```python
import torch

def _softmax(x, axis=-1):
    return torch.softmax(x, dim=axis)
def _gelu(x):
    return torch.nn.functional.gelu(x, approximate="tanh")
def _silu(x):
    return torch.nn.functional.silu(x)
def _sigmoid(x):
    return torch.sigmoid(x)
def _layernorm(x, axis=-1, eps=1e-5):
    m = x.mean(dim=axis, keepdim=True)
    v = x.var(dim=axis, keepdim=True, unbiased=False)
    return (x - m) / torch.sqrt(v + eps)
def _scatter_add(tgt, idx, src, axis=0):
    return tgt.clone().index_add_(axis, idx, src)
def _segment_sum(src, seg, n):
    out = torch.zeros((n,) + src.shape[1:], dtype=src.dtype)
    return out.index_add_(0, seg, src)
def _pad(x, pw):
    flat = tuple(v for pair in reversed(pw) for v in pair)
    return torch.nn.functional.pad(x, flat)

kernel_name = 'concat_heads__ssm_conv_h3__sliding_local_dilated__prompt'

def setup_inputs():

    _w = (lambda a: (lambda t: t.to(torch.bfloat16) if t.is_floating_point() else t)(torch.as_tensor(a)))
    def _A_setup():
        B, S, D = 1, 2048, 640
        ks = 4
        return {
            "q": _w((lambda *s: torch.randn(*s, dtype=torch.bfloat16) * 0.05)(B, S, D)),
            "k": _w((lambda *s: torch.randn(*s, dtype=torch.bfloat16) * 0.8)(B, S, D)),
            "v": _w((lambda *s: torch.randn(*s, dtype=torch.bfloat16) * 0.8)(B, S, D)),
            "shift_k": _w((lambda *s: torch.randn(*s, dtype=torch.bfloat16) * 0.8)(D, ks) * 0.5),
            "ssm_k": _w((lambda *s: torch.randn(*s, dtype=torch.bfloat16) * 3.2)(D, S) * (1.0 / S ** 0.5)),
            "ssm_D": _w((lambda *s: torch.randn(*s, dtype=torch.bfloat16) * 0.8)(D)),
        }
    _A_in = _A_setup()

    def _B_setup():
        B, S, D = 1, 2048, 640
        return {
            "x": _w((lambda *s: torch.randn(*s, dtype=torch.bfloat16) * 0.2)(B, S, D)),
            "wqkv": _w((lambda *s: torch.randn(*s, dtype=torch.bfloat16) * 0.2)(D, 3 * D)),
            "wo": _w((lambda *s: torch.randn(*s, dtype=torch.bfloat16) * 0.05)(D, D)),
        }
    _B_in = _B_setup()

    return {
        "A_q": _A_in["q"],
        "A_k": _A_in["k"],
        "A_v": _A_in["v"],
        "A_shift_k": _A_in["shift_k"],
        "A_ssm_k": _A_in["ssm_k"],
        "A_ssm_D": _A_in["ssm_D"],
        "B_x": _B_in["x"],
        "B_wqkv": _B_in["wqkv"],
        "B_wo": _B_in["wo"],
    }

def reference(A_q, A_k, A_v, A_shift_k, A_ssm_k, A_ssm_D, B_x, B_wqkv, B_wo):
    def _A_ref(q, k, v, shift_k, ssm_k, ssm_D):
        B, S, D = q.shape
        ks = shift_k.shape[-1]
        k_pad = _pad(k, ((0, 0), (ks - 1, 0), (0, 0)))
        k_shift = torch.zeros_like(k)
        for t in range(ks):
            k_shift = k_shift + k_pad[:, t:t + S, :] * shift_k[:, ks - 1 - t][None, None, :]
        kv = k_shift * v
        L = 2 * S
        kv_pad = _pad(kv, ((0, 0), (0, S), (0, 0)))
        kf_pad = _pad(ssm_k, ((0, 0), (0, S)))
        kv_f = (lambda x, axes=(-2,-1): torch.fft.rfft2(x.float(), dim=axes))(kv_pad[:, None, :, :], axes=(1, 2))
        kf_f = (lambda x, axes=(-2,-1): torch.fft.rfft2(x.float(), dim=axes))(kf_pad[:, None, :], axes=(1, 2))
        kf_f = (lambda x, *d: x.permute(*d))(kf_f, 1, 2, 0)
        y_f = kv_f * kf_f[None, :, :, :]
        y = (lambda x, s, axes=(-2,-1): torch.fft.irfft2(x, s=s, dim=axes).to(torch.bfloat16))(y_f, (1, L), axes=(1, 2))[:, 0, :S, :]
        y = y + kv * ssm_D[None, None, :]
        return q * y

    def _B_ref(x, wqkv, wo):
        B, S, D = x.shape
        H = 32; Dh = D // H
        W, dil = 8, 2
        qkv = (lambda x, *d: x.permute(*d))((x @ wqkv).reshape(B, S, 3, H, Dh), 2, 0, 3, 1, 4)
        q, k, v = qkv[0], qkv[1], qkv[2]
        scale = Dh ** -0.5
        pos = torch.arange(S)
        off = torch.arange(W) * dil
        idx = pos[:, None] - off[None, :]
        mask = idx >= 0
        idx_c = torch.where(mask, idx, 0).reshape(-1)
        kg = k[:, :, idx_c, :].reshape(B, H, S, W, Dh)
        vg = v[:, :, idx_c, :].reshape(B, H, S, W, Dh)
        logits = torch.einsum("bhsd,bhswd->bhsw", q, kg) * scale
        logits = torch.where(mask[None, None, :, :], logits, -1e9)
        attn = _softmax(logits, axis=-1)
        o = torch.einsum("bhsw,bhswd->bhsd", attn, vg)
        return (lambda x, *d: x.permute(*d))(o, 0, 2, 1, 3).reshape(B, S, D) @ wo

    a = _A_ref(A_q, A_k, A_v, A_shift_k, A_ssm_k, A_ssm_D)
    b = _B_ref(B_x, B_wqkv, B_wo)
    return torch.concatenate([a, b], axis=-1)
```

```asm
; @launch grid=(256,1,1) block=(512,1,1) lds=163840
.amdgcn_target "amdgcn-amd-amdhsa--gfx950"
.text
.globl concat_heads__ssm_conv_h3__sliding_local_dilated__prompt_kernel
.p2align 8
.type concat_heads__ssm_conv_h3__sliding_local_dilated__prompt_kernel,@function
concat_heads__ssm_conv_h3__sliding_local_dilated__prompt_kernel:
    s_cmp_ge_u32 s2, 256
    s_cbranch_scc1 K_END
    s_load_dwordx16 s[8:23], s[0:1], 0
    s_load_dwordx8 s[24:31], s[0:1], 64
    v_lshrrev_b32 v2, 6, v0
    v_and_b32 v1, 63, v0
    s_and_b32 s4, s2, 7
    v_readfirstlane_b32 s3, v2
    s_lshr_b32 s5, s2, 3
    s_waitcnt lgkmcnt(0)
    s_cmp_lt_u32 s4, 2
    s_cselect_b32 s70, 16, 24
    s_cmp_ge_u32 s5, s70
    s_cbranch_scc1 A_ROLE
    s_cmp_eq_u32 s4, 1
    s_cselect_b32 s71, 1, 0
    s_cmp_ge_u32 s4, 5
    s_cselect_b32 s71, 1, s71
    s_cselect_b32 s7, 3, 0
    s_sub_u32 s6, s4, 2
    s_sub_u32 s6, s6, s7
    s_mul_i32 s6, s6, 3
    s_add_u32 s6, s6, 2
    s_cmp_lt_u32 s4, 2
    s_cselect_b32 s6, 0, s6
    s_lshr_b32 s7, s5, 3
    s_add_u32 s60, s6, s7
    s_and_b32 s68, s5, 7
    s_lshl_b32 s61, s71, 3
    s_add_u32 s61, s61, s68
    s_lshl_b32 s67, s60, 1
    s_add_u32 s67, s67, s71
    s_cmp_ge_u32 s3, 4
    s_cbranch_scc1 BLD_1
    s_mov_b32 s32, s20
    s_mov_b32 s33, s21
    s_mov_b32 s34, 0x280000
    s_mov_b32 s35, 0x00020000
    s_mov_b32 s36, s22
    s_mov_b32 s37, s23
    s_mov_b32 s38, 0x258000
    s_mov_b32 s39, 0x00020000
    s_cmp_eq_u32 s3, 3
    s_cbranch_scc1 IP_3
    s_cmp_eq_u32 s70, 16
    s_cselect_b32 s6, 60, 40
    s_mul_i32 s7, s5, s6
    v_add_u32 v10, s7, v1
    v_mul_u32_u24 v11, 4370, v10
    v_lshrrev_b32 v11, 16, v11
    v_mul_u32_u24 v12, 15, v11
    v_sub_u32 v12, v10, v12
    v_mul_u32_u24 v13, 52, v12
    v_lshrrev_b32 v13, 8, v13
    v_mul_u32_u24 v14, 5, v13
    v_sub_u32 v14, v12, v14
    v_mul_u32_u24 v11, 3840, v11
    v_mul_u32_u24 v13, 1280, v13
    v_lshlrev_b32 v14, 7, v14
    v_add3_u32 v11, v11, v13, v14
    s_mul_i32 s7, s71, 640
    v_add_u32 v11, s7, v11
    v_cmp_gt_u32 vcc, s6, v1
    v_mov_b32 v12, 0x80000000
    s_nop 0
    v_cndmask_b32 v2, v12, v11, vcc
    s_mul_i32 s6, s3, 245760
    buffer_load_dword v254, v2, s[36:39], s6 offen
    s_cmp_eq_u32 s3, 2
    s_cbranch_scc1 IP_3
    v_and_b32 v10, 31, v1
    s_mul_i32 s6, s68, 26
    s_mul_i32 s7, s60, 192
    s_add_u32 s6, s6, s7
    s_sub_u32 s6, s6, 16
    v_add_u32 v11, s6, v10
    s_movk_i32 s7, 1280
    v_mul_lo_u32 v11, v11, s7
    v_lshrrev_b32 v12, 5, v1
    v_lshlrev_b32 v12, 7, v12
    v_add_u32 v11, v11, v12
    v_cmp_gt_u32 vcc, 26, v10
    v_mov_b32 v12, 0x80000000
    s_nop 0
    v_cndmask_b32 v3, v12, v11, vcc
    s_lshl_b32 s6, s3, 8
    buffer_load_dword v255, v3, s[32:35], s6 offen
IP_3:
    s_lshl_b32 s6, s60, 7
    s_add_u32 s6, s6, 49152
    s_add_u32 s52, s30, 0x780000
    s_addc_u32 s53, s31, 0
    s_mov_b32 s54, 0x10000
    s_mov_b32 s55, 0x00020000
    v_mov_b32 v251, s6
    buffer_load_dword v250, v251, s[52:55], 0 offen sc1
    v_and_b32 v10, 15, v1
    v_lshrrev_b32 v11, 4, v1
    v_lshrrev_b32 v12, 1, v10
    v_xor_b32 v12, v12, v11
    v_lshlrev_b32 v12, 4, v12
    v_lshlrev_b32 v10, 7, v10
    v_add_u32 v2, v10, v12
    v_xor_b32 v3, 64, v2
    v_lshrrev_b32 v10, 2, v1
    v_and_b32 v10, 3, v10
    v_and_b32 v12, 3, v1
    v_lshlrev_b32 v13, 3, v11
    v_add_u32 v13, v13, v10
    v_lshlrev_b32 v13, 8, v13
    v_and_b32 v14, 1, v11
    v_lshlrev_b32 v14, 3, v14
    v_lshlrev_b32 v10, 1, v10
    v_add_u32 v14, v14, v10
    v_lshrrev_b32 v15, 1, v12
    s_lshl_b32 s6, s3, 2
    v_add_u32 v15, s6, v15
    v_xor_b32 v15, v15, v14
    v_lshlrev_b32 v15, 4, v15
    v_and_b32 v12, 1, v12
    v_lshlrev_b32 v12, 3, v12
    v_add3_u32 v13, v13, v15, v12
    v_add_u32 v4, 26624, v13
    v_xor_b32 v5, 32, v4
    v_mov_b32 v16, 0
    v_mov_b32 v17, 0
    v_mov_b32 v18, 0
    v_mov_b32 v19, 0
    v_mov_b32 v20, 0
    v_mov_b32 v21, 0
    v_mov_b32 v22, 0
    v_mov_b32 v23, 0
    v_mov_b32 v24, 0
    v_mov_b32 v25, 0
    v_mov_b32 v26, 0
    v_mov_b32 v27, 0
    v_mov_b32 v28, 0
    v_mov_b32 v29, 0
    v_mov_b32 v30, 0
    v_mov_b32 v31, 0
    v_mov_b32 v32, 0
    v_mov_b32 v33, 0
    v_mov_b32 v34, 0
    v_mov_b32 v35, 0
    v_mov_b32 v36, 0
    v_mov_b32 v37, 0
    v_mov_b32 v38, 0
    v_mov_b32 v39, 0
    v_mov_b32 v40, 0
    v_mov_b32 v41, 0
    v_mov_b32 v42, 0
    v_mov_b32 v43, 0
    v_mov_b32 v44, 0
    v_mov_b32 v45, 0
    v_mov_b32 v46, 0
    v_mov_b32 v47, 0
    v_mov_b32 v48, 0
    v_mov_b32 v49, 0
    v_mov_b32 v50, 0
    v_mov_b32 v51, 0
    v_mov_b32 v52, 0
    v_mov_b32 v53, 0
    v_mov_b32 v54, 0
    v_mov_b32 v55, 0
    v_mov_b32 v56, 0
    v_mov_b32 v57, 0
    v_mov_b32 v58, 0
    v_mov_b32 v59, 0
    v_mov_b32 v60, 0
    v_mov_b32 v61, 0
    v_mov_b32 v62, 0
    v_mov_b32 v63, 0
    v_mov_b32 v64, 0
    v_mov_b32 v65, 0
    v_mov_b32 v66, 0
    v_mov_b32 v67, 0
    v_mov_b32 v68, 0
    v_mov_b32 v69, 0
    v_mov_b32 v70, 0
    v_mov_b32 v71, 0
    v_mov_b32 v72, 0
    v_mov_b32 v73, 0
    v_mov_b32 v74, 0
    v_mov_b32 v75, 0
    v_mov_b32 v76, 0
    v_mov_b32 v77, 0
    v_mov_b32 v78, 0
    v_mov_b32 v79, 0
    v_mov_b32 v80, 0
    v_mov_b32 v81, 0
    v_mov_b32 v82, 0
    v_mov_b32 v83, 0
    v_mov_b32 v84, 0
    v_mov_b32 v85, 0
    v_mov_b32 v86, 0
    v_mov_b32 v87, 0
    v_mov_b32 v88, 0
    v_mov_b32 v89, 0
    v_mov_b32 v90, 0
    v_mov_b32 v91, 0
    v_mov_b32 v92, 0
    v_mov_b32 v93, 0
    v_mov_b32 v94, 0
    v_mov_b32 v95, 0
    v_mov_b32 v96, 0
    v_mov_b32 v97, 0
    v_mov_b32 v98, 0
    v_mov_b32 v99, 0
    v_mov_b32 v100, 0
    v_mov_b32 v101, 0
    v_mov_b32 v102, 0
    v_mov_b32 v103, 0
    v_mov_b32 v104, 0
    v_mov_b32 v105, 0
    v_mov_b32 v106, 0
    v_mov_b32 v107, 0
    v_mov_b32 v108, 0
    v_mov_b32 v109, 0
    v_mov_b32 v110, 0
    v_mov_b32 v111, 0
    v_mov_b32 v112, 0
    v_mov_b32 v113, 0
    v_mov_b32 v114, 0
    v_mov_b32 v115, 0
    v_mov_b32 v116, 0
    v_mov_b32 v117, 0
    v_mov_b32 v118, 0
    v_mov_b32 v119, 0
    v_and_b32 v10, 15, v1
    v_lshrrev_b32 v11, 4, v1
    v_mov_b32 v248, 0xf149f2ca
    v_and_b32 v12, 1, v10
    v_cmp_eq_u32 s[64:65], 1, v12
    v_lshlrev_b32 v13, 2, v11
    v_add_u32 v13, v13, v12
    v_cmp_le_u32 s[72:73], v13, v10
    v_add_u32 v13, 2, v13
    v_cmp_le_u32 s[74:75], v13, v10
    v_mov_b32 v14, 0xffff
    v_mov_b32 v15, 0xffff0000
    v_cndmask_b32 v14, v14, v15, s[64:65]
    v_mov_b32 v15, 0
    v_cndmask_b32 v241, v15, v14, s[72:73]
    v_cndmask_b32 v240, v14, v15, s[72:73]
    v_cndmask_b32 v243, v15, v14, s[74:75]
    v_cndmask_b32 v242, v14, v15, s[74:75]
    s_mul_i32 s46, s3, 3
    s_lshr_b32 s6, s46, 1
    s_and_b32 s7, s46, 1
    s_mul_i32 s45, s6, 6400
    s_lshl_b32 s47, s7, 6
    s_add_u32 s45, s45, s47
    s_mul_i32 s47, s6, 1280
    s_mul_i32 s6, s7, 40
    s_add_u32 s47, s47, s6
    s_cmp_eq_u32 s7, 0
    s_cselect_b32 s76, 64, 6336
    s_mov_b32 s77, 6400
    s_cselect_b32 s66, 40, 1240
    s_mov_b32 s78, 1280
    v_mul_u32_u24 v12, 400, v10
    v_lshlrev_b32 v13, 4, v11
    v_add3_u32 v249, v12, v13, s45
    v_lshrrev_b32 v12, 2, v1
    v_and_b32 v12, 3, v12
    v_lshlrev_b32 v13, 2, v11
    v_add_u32 v12, v12, v13
    v_mul_u32_u24 v12, 400, v12
    v_and_b32 v13, 3, v1
    v_lshlrev_b32 v13, 3, v13
    v_add3_u32 v252, v12, v13, s45
    v_mul_u32_u24 v12, 80, v10
    v_lshlrev_b32 v13, 3, v11
    v_add3_u32 v12, v12, v13, s47
    v_add_u32 v253, 83200, v12
    v_and_b32 v10, 15, v1
    v_mul_u32_u24 v10, 400, v10
    v_lshrrev_b32 v11, 4, v1
    s_lshl_b32 s6, s3, 3
    v_add_u32 v11, s6, v11
    v_mul_u32_u24 v6, 52, v11
    v_lshrrev_b32 v6, 8, v6
    v_mul_u32_u24 v7, 5, v6
    v_sub_u32 v7, v11, v7
    v_lshlrev_b32 v6, 6, v6
    v_lshlrev_b32 v7, 3, v7
    v_add3_u32 v12, v10, v6, v7
    v_add_u32 v14, 51200, v12
    v_add_u32 v11, 4, v11
    v_mul_u32_u24 v6, 52, v11
    v_lshrrev_b32 v6, 8, v6
    v_mul_u32_u24 v7, 5, v6
    v_sub_u32 v7, v11, v7
    v_lshlrev_b32 v6, 6, v6
    v_lshlrev_b32 v7, 3, v7
    v_add3_u32 v13, v10, v6, v7
    v_add_u32 v15, 51200, v13
    s_waitcnt vmcnt(0)
    s_barrier
    s_barrier
    v_mov_b32 v6, v2
    v_mov_b32 v7, v3
    v_mov_b32 v8, v4
    v_mov_b32 v9, v5
    ds_read_b64_tr_b16 v[224:225], v8 offset:0
    ds_read_b64_tr_b16 v[226:227], v8 offset:1024
    ds_read_b64_tr_b16 v[228:229], v9 offset:0
    ds_read_b64_tr_b16 v[230:231], v9 offset:1024
    ds_read_b128 v[120:123], v6 offset:0
    ds_read_b128 v[124:127], v6 offset:2048
    ds_read_b128 v[128:131], v6 offset:4096
    ds_read_b128 v[132:135], v6 offset:6144
    ds_read_b128 v[136:139], v6 offset:8192
    ds_read_b128 v[140:143], v6 offset:10240
    ds_read_b128 v[144:147], v6 offset:12288
    ds_read_b128 v[148:151], v6 offset:14336
    ds_read_b128 v[152:155], v6 offset:16384
    ds_read_b128 v[156:159], v6 offset:18432
    ds_read_b128 v[160:163], v6 offset:20480
    ds_read_b128 v[164:167], v6 offset:22528
    ds_read_b128 v[168:171], v6 offset:24576
    s_mov_b32 s40, 0
    s_mov_b32 s44, 0
CL_4:
    s_waitcnt lgkmcnt(0)
    v_mfma_f32_16x16x32_bf16 v[16:19], v[224:227], v[120:123], v[16:19]
    ds_read_b64_tr_b16 v[232:233], v8 offset:8192
    v_mfma_f32_16x16x32_bf16 v[68:71], v[228:231], v[120:123], v[68:71]
    ds_read_b64_tr_b16 v[234:235], v8 offset:9216
    v_mfma_f32_16x16x32_bf16 v[20:23], v[224:227], v[124:127], v[20:23]
    ds_read_b64_tr_b16 v[236:237], v9 offset:8192
    v_mfma_f32_16x16x32_bf16 v[72:75], v[228:231], v[124:127], v[72:75]
    ds_read_b64_tr_b16 v[238:239], v9 offset:9216
    v_mfma_f32_16x16x32_bf16 v[24:27], v[224:227], v[128:131], v[24:27]
    ds_read_b128 v[172:175], v7 offset:0
    v_mfma_f32_16x16x32_bf16 v[76:79], v[228:231], v[128:131], v[76:79]
    ds_read_b128 v[176:179], v7 offset:2048
    v_mfma_f32_16x16x32_bf16 v[28:31], v[224:227], v[132:135], v[28:31]
    ds_read_b128 v[180:183], v7 offset:4096
    v_mfma_f32_16x16x32_bf16 v[80:83], v[228:231], v[132:135], v[80:83]
    ds_read_b128 v[184:187], v7 offset:6144
    v_mfma_f32_16x16x32_bf16 v[32:35], v[224:227], v[136:139], v[32:35]
    ds_read_b128 v[188:191], v7 offset:8192
    v_mfma_f32_16x16x32_bf16 v[84:87], v[228:231], v[136:139], v[84:87]
    ds_read_b128 v[192:195], v7 offset:10240
    v_mfma_f32_16x16x32_bf16 v[36:39], v[224:227], v[140:143], v[36:39]
    ds_read_b128 v[196:199], v7 offset:12288
    v_mfma_f32_16x16x32_bf16 v[88:91], v[228:231], v[140:143], v[88:91]
    ds_read_b128 v[200:203], v7 offset:14336
    v_mfma_f32_16x16x32_bf16 v[40:43], v[224:227], v[144:147], v[40:43]
    ds_read_b128 v[204:207], v7 offset:16384
    v_mfma_f32_16x16x32_bf16 v[92:95], v[228:231], v[144:147], v[92:95]
    ds_read_b128 v[208:211], v7 offset:18432
    v_mfma_f32_16x16x32_bf16 v[44:47], v[224:227], v[148:151], v[44:47]
    ds_read_b128 v[212:215], v7 offset:20480
    v_mfma_f32_16x16x32_bf16 v[96:99], v[228:231], v[148:151], v[96:99]
    ds_read_b128 v[216:219], v7 offset:22528
    v_mfma_f32_16x16x32_bf16 v[48:51], v[224:227], v[152:155], v[48:51]
    ds_read_b128 v[220:223], v7 offset:24576
    v_mfma_f32_16x16x32_bf16 v[100:103], v[228:231], v[152:155], v[100:103]
    v_mfma_f32_16x16x32_bf16 v[52:55], v[224:227], v[156:159], v[52:55]
    v_mfma_f32_16x16x32_bf16 v[104:107], v[228:231], v[156:159], v[104:107]
    v_mfma_f32_16x16x32_bf16 v[56:59], v[224:227], v[160:163], v[56:59]
    v_mfma_f32_16x16x32_bf16 v[108:111], v[228:231], v[160:163], v[108:111]
    v_mfma_f32_16x16x32_bf16 v[60:63], v[224:227], v[164:167], v[60:63]
    v_mfma_f32_16x16x32_bf16 v[112:115], v[228:231], v[164:167], v[112:115]
    v_mfma_f32_16x16x32_bf16 v[64:67], v[224:227], v[168:171], v[64:67]
    v_mfma_f32_16x16x32_bf16 v[116:119], v[228:231], v[168:171], v[116:119]
    s_add_u32 s44, s44, 43008
    s_cmp_ge_u32 s44, 129024
    s_cselect_b32 s44, 0, s44
    v_add_u32 v6, s44, v2
    v_add_u32 v7, s44, v3
    v_add_u32 v8, s44, v4
    v_add_u32 v9, s44, v5
    s_waitcnt lgkmcnt(0)
    s_barrier
    s_cmp_eq_u32 s40, 9
    s_cbranch_scc1 CE_5
    v_mfma_f32_16x16x32_bf16 v[16:19], v[232:235], v[172:175], v[16:19]
    ds_read_b64_tr_b16 v[224:225], v8 offset:0
    v_mfma_f32_16x16x32_bf16 v[68:71], v[236:239], v[172:175], v[68:71]
    ds_read_b64_tr_b16 v[226:227], v8 offset:1024
    v_mfma_f32_16x16x32_bf16 v[20:23], v[232:235], v[176:179], v[20:23]
    ds_read_b64_tr_b16 v[228:229], v9 offset:0
    v_mfma_f32_16x16x32_bf16 v[72:75], v[236:239], v[176:179], v[72:75]
    ds_read_b64_tr_b16 v[230:231], v9 offset:1024
    v_mfma_f32_16x16x32_bf16 v[24:27], v[232:235], v[180:183], v[24:27]
    ds_read_b128 v[120:123], v6 offset:0
    v_mfma_f32_16x16x32_bf16 v[76:79], v[236:239], v[180:183], v[76:79]
    ds_read_b128 v[124:127], v6 offset:2048
    v_mfma_f32_16x16x32_bf16 v[28:31], v[232:235], v[184:187], v[28:31]
    ds_read_b128 v[128:131], v6 offset:4096
    v_mfma_f32_16x16x32_bf16 v[80:83], v[236:239], v[184:187], v[80:83]
    ds_read_b128 v[132:135], v6 offset:6144
    v_mfma_f32_16x16x32_bf16 v[32:35], v[232:235], v[188:191], v[32:35]
    ds_read_b128 v[136:139], v6 offset:8192
    v_mfma_f32_16x16x32_bf16 v[84:87], v[236:239], v[188:191], v[84:87]
    ds_read_b128 v[140:143], v6 offset:10240
    v_mfma_f32_16x16x32_bf16 v[36:39], v[232:235], v[192:195], v[36:39]
    ds_read_b128 v[144:147], v6 offset:12288
    v_mfma_f32_16x16x32_bf16 v[88:91], v[236:239], v[192:195], v[88:91]
    ds_read_b128 v[148:151], v6 offset:14336
    v_mfma_f32_16x16x32_bf16 v[40:43], v[232:235], v[196:199], v[40:43]
    ds_read_b128 v[152:155], v6 offset:16384
    v_mfma_f32_16x16x32_bf16 v[92:95], v[236:239], v[196:199], v[92:95]
    ds_read_b128 v[156:159], v6 offset:18432
    v_mfma_f32_16x16x32_bf16 v[44:47], v[232:235], v[200:203], v[44:47]
    ds_read_b128 v[160:163], v6 offset:20480
    v_mfma_f32_16x16x32_bf16 v[96:99], v[236:239], v[200:203], v[96:99]
    ds_read_b128 v[164:167], v6 offset:22528
    v_mfma_f32_16x16x32_bf16 v[48:51], v[232:235], v[204:207], v[48:51]
    ds_read_b128 v[168:171], v6 offset:24576
    v_mfma_f32_16x16x32_bf16 v[100:103], v[236:239], v[204:207], v[100:103]
    v_mfma_f32_16x16x32_bf16 v[52:55], v[232:235], v[208:211], v[52:55]
    v_mfma_f32_16x16x32_bf16 v[104:107], v[236:239], v[208:211], v[104:107]
    v_mfma_f32_16x16x32_bf16 v[56:59], v[232:235], v[212:215], v[56:59]
    v_mfma_f32_16x16x32_bf16 v[108:111], v[236:239], v[212:215], v[108:111]
    v_mfma_f32_16x16x32_bf16 v[60:63], v[232:235], v[216:219], v[60:63]
    v_mfma_f32_16x16x32_bf16 v[112:115], v[236:239], v[216:219], v[112:115]
    v_mfma_f32_16x16x32_bf16 v[64:67], v[232:235], v[220:223], v[64:67]
    v_mfma_f32_16x16x32_bf16 v[116:119], v[236:239], v[220:223], v[116:119]
    s_add_u32 s40, s40, 1
    s_branch CL_4
CE_5:
    v_mfma_f32_16x16x32_bf16 v[16:19], v[232:235], v[172:175], v[16:19]
    v_mfma_f32_16x16x32_bf16 v[68:71], v[236:239], v[172:175], v[68:71]
    v_mfma_f32_16x16x32_bf16 v[20:23], v[232:235], v[176:179], v[20:23]
    v_mfma_f32_16x16x32_bf16 v[72:75], v[236:239], v[176:179], v[72:75]
    v_mfma_f32_16x16x32_bf16 v[24:27], v[232:235], v[180:183], v[24:27]
    v_mfma_f32_16x16x32_bf16 v[76:79], v[236:239], v[180:183], v[76:79]
    v_mfma_f32_16x16x32_bf16 v[28:31], v[232:235], v[184:187], v[28:31]
    v_mfma_f32_16x16x32_bf16 v[80:83], v[236:239], v[184:187], v[80:83]
    v_mfma_f32_16x16x32_bf16 v[32:35], v[232:235], v[188:191], v[32:35]
    v_cvt_pk_bf16_f32 v120, v16, v17
    v_cvt_pk_bf16_f32 v121, v18, v19
    ds_write_b64 v12, v[120:121] offset:0
    v_mfma_f32_16x16x32_bf16 v[84:87], v[236:239], v[188:191], v[84:87]
    v_cvt_pk_bf16_f32 v122, v68, v69
    v_cvt_pk_bf16_f32 v123, v70, v71
    ds_write_b64 v13, v[122:123] offset:0
    v_mfma_f32_16x16x32_bf16 v[36:39], v[232:235], v[192:195], v[36:39]
    v_cvt_pk_bf16_f32 v124, v20, v21
    v_cvt_pk_bf16_f32 v125, v22, v23
    ds_write_b64 v12, v[124:125] offset:6400
    v_mfma_f32_16x16x32_bf16 v[88:91], v[236:239], v[192:195], v[88:91]
    v_cvt_pk_bf16_f32 v126, v72, v73
    v_cvt_pk_bf16_f32 v127, v74, v75
    ds_write_b64 v13, v[126:127] offset:6400
    v_mfma_f32_16x16x32_bf16 v[40:43], v[232:235], v[196:199], v[40:43]
    v_cvt_pk_bf16_f32 v128, v24, v25
    v_cvt_pk_bf16_f32 v129, v26, v27
    ds_write_b64 v12, v[128:129] offset:12800
    v_mfma_f32_16x16x32_bf16 v[92:95], v[236:239], v[196:199], v[92:95]
    v_cvt_pk_bf16_f32 v130, v76, v77
    v_cvt_pk_bf16_f32 v131, v78, v79
    ds_write_b64 v13, v[130:131] offset:12800
    v_mfma_f32_16x16x32_bf16 v[44:47], v[232:235], v[200:203], v[44:47]
    v_cvt_pk_bf16_f32 v132, v28, v29
    v_cvt_pk_bf16_f32 v133, v30, v31
    ds_write_b64 v12, v[132:133] offset:19200
    v_mfma_f32_16x16x32_bf16 v[96:99], v[236:239], v[200:203], v[96:99]
    v_cvt_pk_bf16_f32 v134, v80, v81
    v_cvt_pk_bf16_f32 v135, v82, v83
    ds_write_b64 v13, v[134:135] offset:19200
    v_mfma_f32_16x16x32_bf16 v[48:51], v[232:235], v[204:207], v[48:51]
    v_cvt_pk_bf16_f32 v136, v32, v33
    v_cvt_pk_bf16_f32 v137, v34, v35
    ds_write_b64 v12, v[136:137] offset:25600
    v_mfma_f32_16x16x32_bf16 v[100:103], v[236:239], v[204:207], v[100:103]
    v_cvt_pk_bf16_f32 v138, v84, v85
    v_cvt_pk_bf16_f32 v139, v86, v87
    ds_write_b64 v13, v[138:139] offset:25600
    v_mfma_f32_16x16x32_bf16 v[52:55], v[232:235], v[208:211], v[52:55]
    v_cvt_pk_bf16_f32 v140, v36, v37
    v_cvt_pk_bf16_f32 v141, v38, v39
    ds_write_b64 v12, v[140:141] offset:32000
    v_mfma_f32_16x16x32_bf16 v[104:107], v[236:239], v[208:211], v[104:107]
    v_cvt_pk_bf16_f32 v142, v88, v89
    v_cvt_pk_bf16_f32 v143, v90, v91
    ds_write_b64 v13, v[142:143] offset:32000
    v_mfma_f32_16x16x32_bf16 v[56:59], v[232:235], v[212:215], v[56:59]
    v_cvt_pk_bf16_f32 v144, v40, v41
    v_cvt_pk_bf16_f32 v145, v42, v43
    ds_write_b64 v12, v[144:145] offset:38400
    v_mfma_f32_16x16x32_bf16 v[108:111], v[236:239], v[212:215], v[108:111]
    v_cvt_pk_bf16_f32 v146, v92, v93
    v_cvt_pk_bf16_f32 v147, v94, v95
    ds_write_b64 v13, v[146:147] offset:38400
    v_mfma_f32_16x16x32_bf16 v[60:63], v[232:235], v[216:219], v[60:63]
    v_cvt_pk_bf16_f32 v148, v44, v45
    v_cvt_pk_bf16_f32 v149, v46, v47
    ds_write_b64 v12, v[148:149] offset:44800
    v_mfma_f32_16x16x32_bf16 v[112:115], v[236:239], v[216:219], v[112:115]
    v_cvt_pk_bf16_f32 v150, v96, v97
    v_cvt_pk_bf16_f32 v151, v98, v99
    ds_write_b64 v13, v[150:151] offset:44800
    v_mfma_f32_16x16x32_bf16 v[64:67], v[232:235], v[220:223], v[64:67]
    v_cvt_pk_bf16_f32 v120, v48, v49
    v_cvt_pk_bf16_f32 v121, v50, v51
    ds_write_b64 v14, v[120:121] offset:0
    v_mfma_f32_16x16x32_bf16 v[116:119], v[236:239], v[220:223], v[116:119]
    v_cvt_pk_bf16_f32 v122, v100, v101
    v_cvt_pk_bf16_f32 v123, v102, v103
    ds_write_b64 v15, v[122:123] offset:0
    s_nop 7
    v_cvt_pk_bf16_f32 v124, v52, v53
    v_cvt_pk_bf16_f32 v125, v54, v55
    ds_write_b64 v14, v[124:125] offset:6400
    v_cvt_pk_bf16_f32 v126, v104, v105
    v_cvt_pk_bf16_f32 v127, v106, v107
    ds_write_b64 v15, v[126:127] offset:6400
    v_cvt_pk_bf16_f32 v128, v56, v57
    v_cvt_pk_bf16_f32 v129, v58, v59
    ds_write_b64 v14, v[128:129] offset:12800
    v_cvt_pk_bf16_f32 v130, v108, v109
    v_cvt_pk_bf16_f32 v131, v110, v111
    ds_write_b64 v15, v[130:131] offset:12800
    v_cvt_pk_bf16_f32 v132, v60, v61
    v_cvt_pk_bf16_f32 v133, v62, v63
    ds_write_b64 v14, v[132:133] offset:19200
    v_cvt_pk_bf16_f32 v134, v112, v113
    v_cvt_pk_bf16_f32 v135, v114, v115
    ds_write_b64 v15, v[134:135] offset:19200
    v_cvt_pk_bf16_f32 v136, v64, v65
    v_cvt_pk_bf16_f32 v137, v66, v67
    ds_write_b64 v14, v[136:137] offset:25600
    v_cvt_pk_bf16_f32 v138, v116, v117
    v_cvt_pk_bf16_f32 v139, v118, v119
    ds_write_b64 v15, v[138:139] offset:25600
    s_waitcnt lgkmcnt(0)
    s_branch BJ1_2
BLD_1:
    s_lshl_b32 s6, s60, 7
    s_add_u32 s6, s6, 49152
    s_add_u32 s52, s30, 0x780000
    s_addc_u32 s53, s31, 0
    s_mov_b32 s54, 0x10000
    s_mov_b32 s55, 0x00020000
    v_mov_b32 v251, s6
    buffer_load_dword v250, v251, s[52:55], 0 offen sc1
    s_mov_b32 s32, s20
    s_mov_b32 s33, s21
    s_mov_b32 s34, 0x280000
    s_mov_b32 s35, 0x00020000
    s_mov_b32 s36, s22
    s_mov_b32 s37, s23
    s_mov_b32 s38, 0x258000
    s_mov_b32 s39, 0x00020000
    s_sub_u32 s62, s3, 4
    v_lshrrev_b32 v10, 3, v1
    s_lshl_b32 s6, s62, 3
    v_add_u32 v10, s6, v10
    v_lshrrev_b32 v11, 1, v10
    v_and_b32 v11, 7, v11
    v_and_b32 v12, 7, v1
    v_xor_b32 v11, v11, v12
    v_lshlrev_b32 v11, 4, v11
    s_mul_i32 s6, s60, 192
    s_sub_u32 s6, s6, 16
    v_add_u32 v10, s6, v10
    s_movk_i32 s7, 1280
    v_mul_lo_u32 v10, v10, s7
    v_add_u32 v2, v10, v11
    v_add_u32 v3, 40960, v2
    v_lshrrev_b32 v10, 4, v1
    v_and_b32 v12, 15, v1
    s_mul_i32 s63, s61, 80
    v_lshlrev_b32 v11, 1, v10
    v_xor_b32 v11, v11, v12
    v_mul_u32_u24 v13, 52, v11
    v_lshrrev_b32 v13, 8, v13
    v_mul_u32_u24 v14, 5, v13
    v_sub_u32 v14, v11, v14
    v_mul_u32_u24 v13, 1280, v13
    v_lshlrev_b32 v14, 4, v14
    v_add3_u32 v13, v13, v14, s63
    s_lshl_b32 s6, s62, 4
    v_add_u32 v14, s6, v10
    v_mul_u32_u24 v14, 3840, v14
    v_add_u32 v5, v14, v13
    v_cmp_eq_u32 vcc, 15, v11
    v_mov_b32 v13, 0x80000000
    s_nop 0
    v_cndmask_b32 v5, v5, v13, vcc
    v_lshlrev_b32 v11, 1, v10
    v_add_u32 v11, 8, v11
    v_xor_b32 v11, v11, v12
    v_mul_u32_u24 v13, 52, v11
    v_lshrrev_b32 v13, 8, v13
    v_mul_u32_u24 v14, 5, v13
    v_sub_u32 v14, v11, v14
    v_mul_u32_u24 v13, 1280, v13
    v_lshlrev_b32 v14, 4, v14
    v_add3_u32 v13, v13, v14, s63
    s_lshl_b32 s6, s62, 4
    s_add_u32 s6, s6, 8
    v_add_u32 v14, s6, v10
    v_mul_u32_u24 v14, 3840, v14
    v_add_u32 v6, v14, v13
    v_cmp_eq_u32 vcc, 15, v11
    v_mov_b32 v13, 0x80000000
    s_nop 0
    v_cndmask_b32 v6, v6, v13, vcc
    s_mov_b32 s41, 0
    s_mov_b32 s42, 0
    s_mov_b32 s43, 0
    s_mov_b32 s56, s24
    s_mov_b32 s57, s25
    s_mov_b32 s58, 0xc8000
    s_mov_b32 s59, 0x00020000
    v_add_u32 v10, 0, v1
    v_mul_u32_u24 v11, 6554, v10
    v_lshrrev_b32 v11, 16, v11
    v_mul_u32_u24 v12, 10, v11
    v_sub_u32 v12, v10, v12
    v_lshrrev_b32 v13, 4, v11
    v_lshlrev_b32 v13, 2, v13
    v_and_b32 v14, 3, v11
    v_add_u32 v13, v13, v14
    v_lshrrev_b32 v14, 2, v11
    v_and_b32 v14, 3, v14
    v_lshlrev_b32 v14, 3, v14
    v_add_u32 v13, v13, v14
    v_mul_u32_u24 v13, 1280, v13
    v_lshlrev_b32 v12, 4, v12
    s_mul_i32 s6, s68, 160
    v_add3_u32 v230, v13, v12, s6
    v_add_u32 v10, 64, v1
    v_mul_u32_u24 v11, 6554, v10
    v_lshrrev_b32 v11, 16, v11
    v_mul_u32_u24 v12, 10, v11
    v_sub_u32 v12, v10, v12
    v_lshrrev_b32 v13, 4, v11
    v_lshlrev_b32 v13, 2, v13
    v_and_b32 v14, 3, v11
    v_add_u32 v13, v13, v14
    v_lshrrev_b32 v14, 2, v11
    v_and_b32 v14, 3, v14
    v_lshlrev_b32 v14, 3, v14
    v_add_u32 v13, v13, v14
    v_mul_u32_u24 v13, 1280, v13
    v_lshlrev_b32 v12, 4, v12
    s_mul_i32 s6, s68, 160
    v_add3_u32 v231, v13, v12, s6
    v_add_u32 v10, 128, v1
    v_mul_u32_u24 v11, 6554, v10
    v_lshrrev_b32 v11, 16, v11
    v_mul_u32_u24 v12, 10, v11
    v_sub_u32 v12, v10, v12
    v_lshrrev_b32 v13, 4, v11
    v_lshlrev_b32 v13, 2, v13
    v_and_b32 v14, 3, v11
    v_add_u32 v13, v13, v14
    v_lshrrev_b32 v14, 2, v11
    v_and_b32 v14, 3, v14
    v_lshlrev_b32 v14, 3, v14
    v_add_u32 v13, v13, v14
    v_mul_u32_u24 v13, 1280, v13
    v_lshlrev_b32 v12, 4, v12
    s_mul_i32 s6, s68, 160
    v_add3_u32 v232, v13, v12, s6
    v_add_u32 v10, 192, v1
    v_mul_u32_u24 v11, 6554, v10
    v_lshrrev_b32 v11, 16, v11
    v_mul_u32_u24 v12, 10, v11
    v_sub_u32 v12, v10, v12
    v_lshrrev_b32 v13, 4, v11
    v_lshlrev_b32 v13, 2, v13
    v_and_b32 v14, 3, v11
    v_add_u32 v13, v13, v14
    v_lshrrev_b32 v14, 2, v11
    v_and_b32 v14, 3, v14
    v_lshlrev_b32 v14, 3, v14
    v_add_u32 v13, v13, v14
    v_mul_u32_u24 v13, 1280, v13
    v_lshlrev_b32 v12, 4, v12
    s_mul_i32 s6, s68, 160
    v_add3_u32 v233, v13, v12, s6
    v_add_u32 v10, 256, v1
    v_mul_u32_u24 v11, 6554, v10
    v_lshrrev_b32 v11, 16, v11
    v_mul_u32_u24 v12, 10, v11
    v_sub_u32 v12, v10, v12
    v_lshrrev_b32 v13, 4, v11
    v_lshlrev_b32 v13, 2, v13
    v_and_b32 v14, 3, v11
    v_add_u32 v13, v13, v14
    v_lshrrev_b32 v14, 2, v11
    v_and_b32 v14, 3, v14
    v_lshlrev_b32 v14, 3, v14
    v_add_u32 v13, v13, v14
    v_mul_u32_u24 v13, 1280, v13
    v_lshlrev_b32 v12, 4, v12
    s_mul_i32 s6, s68, 160
    v_add3_u32 v234, v13, v12, s6
    v_and_b32 v10, 15, v1
    v_lshrrev_b32 v11, 4, v1
    v_mov_b32 v248, 0xf149f2ca
    v_and_b32 v12, 1, v10
    v_cmp_eq_u32 s[64:65], 1, v12
    v_lshlrev_b32 v13, 2, v11
    v_add_u32 v13, v13, v12
    v_cmp_le_u32 s[72:73], v13, v10
    v_add_u32 v13, 2, v13
    v_cmp_le_u32 s[74:75], v13, v10
    v_mov_b32 v14, 0xffff
    v_mov_b32 v15, 0xffff0000
    v_cndmask_b32 v14, v14, v15, s[64:65]
    v_mov_b32 v15, 0
    v_cndmask_b32 v241, v15, v14, s[72:73]
    v_cndmask_b32 v240, v14, v15, s[72:73]
    v_cndmask_b32 v243, v15, v14, s[74:75]
    v_cndmask_b32 v242, v14, v15, s[74:75]
    s_mul_i32 s46, s3, 3
    s_lshr_b32 s6, s46, 1
    s_and_b32 s7, s46, 1
    s_mul_i32 s45, s6, 6400
    s_lshl_b32 s47, s7, 6
    s_add_u32 s45, s45, s47
    s_mul_i32 s47, s6, 1280
    s_mul_i32 s6, s7, 40
    s_add_u32 s47, s47, s6
    s_cmp_eq_u32 s7, 0
    s_cselect_b32 s76, 64, 6336
    s_mov_b32 s77, 6400
    s_cselect_b32 s66, 40, 1240
    s_mov_b32 s78, 1280
    v_mul_u32_u24 v12, 400, v10
    v_lshlrev_b32 v13, 4, v11
    v_add3_u32 v249, v12, v13, s45
    v_lshrrev_b32 v12, 2, v1
    v_and_b32 v12, 3, v12
    v_lshlrev_b32 v13, 2, v11
    v_add_u32 v12, v12, v13
    v_mul_u32_u24 v12, 400, v12
    v_and_b32 v13, 3, v1
    v_lshlrev_b32 v13, 3, v13
    v_add3_u32 v252, v12, v13, s45
    v_mul_u32_u24 v12, 80, v10
    v_lshlrev_b32 v13, 3, v11
    v_add3_u32 v12, v12, v13, s47
    v_add_u32 v253, 83200, v12
    v_and_b32 v10, 255, v0
    v_lshlrev_b32 v10, 4, v10
    v_add_u32 v216, 83200, v10
    s_mul_i32 s6, s61, 163840
    s_mul_i32 s7, s60, 15360
    s_add_u32 s6, s6, s7
    v_add_u32 v12, s6, v10
    s_movk_i32 s7, 15360
    s_cmp_eq_u32 s60, 10
    s_cselect_b32 s7, 10240, s7
    v_mov_b32 v14, 0x80000000
    v_add_u32 v217, 0, v12
    v_add_u32 v13, 0, v10
    v_cmp_gt_u32 vcc, s7, v13
    s_nop 1
    v_cndmask_b32 v217, v14, v217, vcc
    v_add_u32 v218, 4096, v12
    v_add_u32 v13, 4096, v10
    v_cmp_gt_u32 vcc, s7, v13
    s_nop 1
    v_cndmask_b32 v218, v14, v218, vcc
    v_add_u32 v219, 8192, v12
    v_add_u32 v13, 8192, v10
    v_cmp_gt_u32 vcc, s7, v13
    s_nop 1
    v_cndmask_b32 v219, v14, v219, vcc
    v_add_u32 v220, 12288, v12
    v_add_u32 v13, 12288, v10
    v_cmp_gt_u32 vcc, s7, v13
    s_nop 1
    v_cndmask_b32 v220, v14, v220, vcc
    s_mov_b32 s48, s30
    s_mov_b32 s49, s31
    s_mov_b32 s50, 0x280000
    s_mov_b32 s51, 0x00020000
    s_barrier
    s_mov_b32 s40, 0
LP_6:
    s_lshl_b32 s6, s62, 10
    s_add_u32 s6, s6, s43
    s_mov_b32 m0, s6
    s_mov_b32 s7, s41
    buffer_load_dwordx4 v2, s[32:35], s41 offen  lds
    s_add_u32 m0, s6, 4096
    s_nop 0
    buffer_load_dwordx4 v3, s[32:35], s7 offen  lds
    s_add_u32 m0, s6, 8192
    s_add_u32 s7, s7, 40960
    buffer_load_dwordx4 v3, s[32:35], s7 offen  lds
    s_add_u32 m0, s6, 12288
    s_add_u32 s7, s7, 40960
    buffer_load_dwordx4 v3, s[32:35], s7 offen  lds
    s_add_u32 m0, s6, 16384
    s_add_u32 s7, s7, 40960
    buffer_load_dwordx4 v3, s[32:35], s7 offen  lds
    s_add_u32 m0, s6, 20480
    s_add_u32 s7, s7, 40960
    buffer_load_dwordx4 v3, s[32:35], s7 offen  lds
    s_cmp_lt_u32 s62, 2
    s_cbranch_scc0 IS_7
    s_add_u32 m0, s6, 24576
    s_add_u32 s7, s7, 40960
    buffer_load_dwordx4 v3, s[32:35], s7 offen  lds
IS_7:
    s_lshl_b32 s7, s62, 12
    s_add_u32 s7, s7, s43
    s_add_u32 s7, s7, 26624
    s_mov_b32 m0, s7
    s_add_u32 s46, s42, 15360
    buffer_load_dwordx4 v5, s[36:39], s42 offen  lds
    s_add_u32 m0, s7, 1024
    s_nop 0
    buffer_load_dwordx4 v5, s[36:39], s46 offen  lds
    s_add_u32 m0, s7, 2048
    s_nop 0
    buffer_load_dwordx4 v6, s[36:39], s42 offen  lds
    s_add_u32 m0, s7, 3072
    s_nop 0
    buffer_load_dwordx4 v6, s[36:39], s46 offen  lds
    s_add_u32 s41, s41, 128
    s_add_u32 s42, s42, 245760
    s_add_u32 s43, s43, 43008
    s_cmp_ge_u32 s43, 129024
    s_cselect_b32 s43, 0, s43
    s_add_u32 s40, s40, 1
    s_cmp_eq_u32 s40, 2
    s_cbranch_scc0 LP_8
    s_cmp_lt_u32 s62, 2
    s_cbranch_scc0 LW_9
    s_waitcnt vmcnt(11)
    s_branch LW_10
LW_9:
    s_waitcnt vmcnt(10)
LW_10:
    s_barrier
LP_8:
    s_cmp_lt_u32 s40, 3
    s_cbranch_scc1 LP_6
    s_mov_b32 s40, 0
LL_11:
    s_cmp_lt_u32 s40, 2
    s_cbranch_scc1 LLx_12
    s_cmp_lt_u32 s40, 8
    s_cbranch_scc1 LLx_13
    s_cmp_eq_u32 s40, 8
    s_cbranch_scc1 LLx_14
    s_branch LLx_16
LLx_12:
    s_cmp_lt_u32 s62, 2
    s_cbranch_scc0 LW_17
    s_waitcnt vmcnt(11)
    s_branch LW_18
LW_17:
    s_waitcnt vmcnt(10)
LW_18:
    s_branch LLx_16
LLx_13:
    s_cmp_lt_u32 s62, 2
    s_cbranch_scc0 LW_19
    s_waitcnt vmcnt(11)
    s_branch LW_20
LW_19:
    s_waitcnt vmcnt(10)
LW_20:
    s_branch LLx_16
LLx_14:
    s_waitcnt vmcnt(5)
LLx_16:
    s_barrier
    s_cmp_ge_u32 s40, 7
    s_cbranch_scc1 LLS_21
    s_lshl_b32 s6, s62, 10
    s_add_u32 s6, s6, s43
    s_mov_b32 m0, s6
    s_mov_b32 s7, s41
    buffer_load_dwordx4 v2, s[32:35], s41 offen  lds
    s_add_u32 m0, s6, 4096
    s_nop 0
    buffer_load_dwordx4 v3, s[32:35], s7 offen  lds
    s_add_u32 m0, s6, 8192
    s_add_u32 s7, s7, 40960
    buffer_load_dwordx4 v3, s[32:35], s7 offen  lds
    s_add_u32 m0, s6, 12288
    s_add_u32 s7, s7, 40960
    buffer_load_dwordx4 v3, s[32:35], s7 offen  lds
    s_add_u32 m0, s6, 16384
    s_add_u32 s7, s7, 40960
    buffer_load_dwordx4 v3, s[32:35], s7 offen  lds
    s_add_u32 m0, s6, 20480
    s_add_u32 s7, s7, 40960
    buffer_load_dwordx4 v3, s[32:35], s7 offen  lds
    s_cmp_lt_u32 s62, 2
    s_cbranch_scc0 IS_25
    s_add_u32 m0, s6, 24576
    s_add_u32 s7, s7, 40960
    buffer_load_dwordx4 v3, s[32:35], s7 offen  lds
IS_25:
    s_lshl_b32 s7, s62, 12
    s_add_u32 s7, s7, s43
    s_add_u32 s7, s7, 26624
    s_mov_b32 m0, s7
    s_add_u32 s46, s42, 15360
    buffer_load_dwordx4 v5, s[36:39], s42 offen  lds
    s_add_u32 m0, s7, 1024
    s_nop 0
    buffer_load_dwordx4 v5, s[36:39], s46 offen  lds
    s_add_u32 m0, s7, 2048
    s_nop 0
    buffer_load_dwordx4 v6, s[36:39], s42 offen  lds
    s_add_u32 m0, s7, 3072
    s_nop 0
    buffer_load_dwordx4 v6, s[36:39], s46 offen  lds
    s_add_u32 s41, s41, 128
    s_add_u32 s42, s42, 245760
    s_add_u32 s43, s43, 43008
    s_cmp_ge_u32 s43, 129024
    s_cselect_b32 s43, 0, s43
    s_branch LLN_24
LLS_21:
    s_cmp_eq_u32 s40, 7
    s_cbranch_scc0 LL8_23
    s_add_u32 s47, s62, 5
WO_26:
    s_cmp_ge_u32 s47, 11
    s_cbranch_scc1 WO_27
    s_mul_i32 s6, s47, 52
    s_lshr_b32 s6, s6, 8
    s_mul_i32 s7, s6, 5
    s_sub_u32 s7, s47, s7
    s_add_u32 s6, s6, s68
    s_and_b32 s6, s6, 3
    s_mul_i32 s6, s6, 5
    s_add_u32 s7, s7, s6
    s_mul_i32 s7, s7, 40960
    s_mul_i32 s6, s47, 5120
    s_add_u32 s6, s6, 0x1a400
    s_add_u32 m0, s6, 0
    s_nop 0
    buffer_load_dwordx4 v230, s[56:59], s7 offen lds
    s_add_u32 m0, s6, 1024
    s_nop 0
    buffer_load_dwordx4 v231, s[56:59], s7 offen lds
    s_add_u32 m0, s6, 2048
    s_nop 0
    buffer_load_dwordx4 v232, s[56:59], s7 offen lds
    s_add_u32 m0, s6, 3072
    s_nop 0
    buffer_load_dwordx4 v233, s[56:59], s7 offen lds
    s_add_u32 m0, s6, 4096
    s_nop 0
    buffer_load_dwordx4 v234, s[56:59], s7 offen lds
    s_add_u32 s47, s47, 4
    s_branch WO_26
WO_27:
    s_branch LLN_24
LL8_23:
    s_cmp_eq_u32 s40, 8
    s_cbranch_scc0 LL9_28
    s_add_u32 s47, s62, 0
WO_29:
    s_cmp_ge_u32 s47, 5
    s_cbranch_scc1 WO_30
    s_mul_i32 s6, s47, 52
    s_lshr_b32 s6, s6, 8
    s_mul_i32 s7, s6, 5
    s_sub_u32 s7, s47, s7
    s_add_u32 s6, s6, s68
    s_and_b32 s6, s6, 3
    s_mul_i32 s6, s6, 5
    s_add_u32 s7, s7, s6
    s_mul_i32 s7, s7, 40960
    s_mul_i32 s6, s47, 5120
    s_add_u32 s6, s6, 0x19000
    s_add_u32 m0, s6, 0
    s_nop 0
    buffer_load_dwordx4 v230, s[56:59], s7 offen lds
    s_add_u32 m0, s6, 1024
    s_nop 0
    buffer_load_dwordx4 v231, s[56:59], s7 offen lds
    s_add_u32 m0, s6, 2048
    s_nop 0
    buffer_load_dwordx4 v232, s[56:59], s7 offen lds
    s_add_u32 m0, s6, 3072
    s_nop 0
    buffer_load_dwordx4 v233, s[56:59], s7 offen lds
    s_add_u32 m0, s6, 4096
    s_nop 0
    buffer_load_dwordx4 v234, s[56:59], s7 offen lds
    s_add_u32 s47, s47, 4
    s_branch WO_29
WO_30:
    s_branch LLN_24
LL9_28:
    s_add_u32 s6, s68, 2
    s_and_b32 s6, s6, 3
    s_mul_i32 s6, s6, 160
    s_mul_i32 s7, s62, 40
    s_add_u32 s6, s6, s7
    v_add_u32 v10, s6, v1
    v_mul_u32_u24 v10, 1280, v10
    s_mul_i32 s6, s68, 160
    s_and_b32 s6, s6, 0xffffff80
    v_add_u32 v10, s6, v10
    v_mov_b32 v11, 0x80000000
    v_cmp_gt_u32 vcc, 40, v1
    s_nop 1
    v_cndmask_b32 v10, v11, v10, vcc
    buffer_load_dword v235, v10, s[56:59], 0 offen
    buffer_load_dword v236, v10, s[56:59], 0 offen offset:128
    s_add_u32 s6, s68, 3
    s_and_b32 s6, s6, 3
    s_mul_i32 s6, s6, 160
    s_mul_i32 s7, s62, 40
    s_add_u32 s6, s6, s7
    v_add_u32 v10, s6, v1
    v_mul_u32_u24 v10, 1280, v10
    s_mul_i32 s6, s68, 160
    s_and_b32 s6, s6, 0xffffff80
    v_add_u32 v10, s6, v10
    v_mov_b32 v11, 0x80000000
    v_cmp_gt_u32 vcc, 40, v1
    s_nop 1
    v_cndmask_b32 v10, v11, v10, vcc
    buffer_load_dword v237, v10, s[56:59], 0 offen
    buffer_load_dword v238, v10, s[56:59], 0 offen offset:128
LLN_24:
    s_add_u32 s40, s40, 1
    s_cmp_lt_u32 s40, 10
    s_cbranch_scc1 LL_11
    v_and_b32 v10, 255, v0
    v_mov_b32 v16, 0
    v_mov_b32 v17, 0
    v_mov_b32 v18, 0
    v_mov_b32 v19, 0
    v_lshrrev_b32 v11, 2, v10
    v_and_b32 v12, 3, v10
    v_mul_u32_u24 v11, 400, v11
    v_lshlrev_b32 v12, 6, v12
    v_add_u32 v11, v11, v12
    ds_write_b64 v11, v[16:17] offset:40
    ds_write_b128 v11, v[16:19] offset:48
    ds_write_b64 v11, v[16:17] offset:25640
    ds_write_b128 v11, v[16:19] offset:25648
    v_add_u32 v11, 51200, v11
    ds_write_b64 v11, v[16:17] offset:40
    ds_write_b128 v11, v[16:19] offset:48
    v_cmp_gt_u32 vcc, 64, v10
    s_and_saveexec_b64 s[6:7], vcc
    ds_write_b64 v11, v[16:17] offset:25640
    ds_write_b128 v11, v[16:19] offset:25648
    s_mov_b64 exec, s[6:7]
    s_waitcnt lgkmcnt(0)
BJ1_2:
    s_barrier
    v_add_u32 v116, s76, v249
    v_add_u32 v164, s77, v249
    ds_read_b128 v[32:35], v249 offset:6400
    ds_read_b128 v[36:39], v249 offset:128
    ds_read_b128 v[40:43], v249 offset:6528
    ds_read_b128 v[80:83], v116 offset:6400
    ds_read_b128 v[84:87], v116 offset:128
    ds_read_b128 v[88:91], v116 offset:6528
    ds_read_b128 v[128:131], v164 offset:6400
    ds_read_b128 v[132:135], v164 offset:128
    ds_read_b128 v[136:139], v164 offset:6528
    v_add_u32 v117, s76, v252
    v_add_u32 v165, s77, v252
    ds_read_b64_tr_b16 v[44:45], v252 offset:256
    ds_read_b64_tr_b16 v[46:47], v252 offset:6656
    ds_read_b64_tr_b16 v[48:49], v252 offset:288
    ds_read_b64_tr_b16 v[50:51], v252 offset:6688
    ds_read_b64_tr_b16 v[92:93], v117 offset:256
    ds_read_b64_tr_b16 v[94:95], v117 offset:6656
    ds_read_b64_tr_b16 v[96:97], v117 offset:288
    ds_read_b64_tr_b16 v[98:99], v117 offset:6688
    ds_read_b64_tr_b16 v[140:141], v165 offset:256
    ds_read_b64_tr_b16 v[142:143], v165 offset:6656
    ds_read_b64_tr_b16 v[144:145], v165 offset:288
    ds_read_b64_tr_b16 v[146:147], v165 offset:6688
    v_add_u32 v118, s66, v253
    v_add_u32 v166, s78, v253
    s_mov_b32 s45, 0x3ea52b5c
    s_waitcnt lgkmcnt(12)
    v_mfma_f32_16x16x32_bf16 v[52:55], v[36:39], v[32:35], 0
    v_mfma_f32_16x16x32_bf16 v[56:59], v[40:43], v[32:35], 0
    v_mfma_f32_16x16x32_bf16 v[100:103], v[84:87], v[80:83], 0
    v_mfma_f32_16x16x32_bf16 v[104:107], v[88:91], v[80:83], 0
    v_mfma_f32_16x16x32_bf16 v[148:151], v[132:135], v[128:131], 0
    v_mfma_f32_16x16x32_bf16 v[152:155], v[136:139], v[128:131], 0
    s_nop 7
    v_cndmask_b32 v52, v52, v53, s[64:65]
    v_cndmask_b32 v100, v100, v101, s[64:65]
    v_cndmask_b32 v148, v148, v149, s[64:65]
    v_cndmask_b32 v54, v54, v55, s[64:65]
    v_cndmask_b32 v102, v102, v103, s[64:65]
    v_cndmask_b32 v150, v150, v151, s[64:65]
    v_cndmask_b32 v56, v56, v57, s[64:65]
    v_cndmask_b32 v104, v104, v105, s[64:65]
    v_cndmask_b32 v152, v152, v153, s[64:65]
    v_cndmask_b32 v58, v58, v59, s[64:65]
    v_cndmask_b32 v106, v106, v107, s[64:65]
    v_cndmask_b32 v154, v154, v155, s[64:65]
    s_or_b32 s6, s60, s3
    s_cmp_lg_u32 s6, 0
    s_cbranch_scc1 ATS_31
    v_mov_b32 v52, v248
    v_mov_b32 v54, v248
    v_mov_b32 v100, v248
    v_mov_b32 v102, v248
ATS_31:
    v_cndmask_b32 v52, v52, v56, s[72:73]
    v_cndmask_b32 v100, v100, v104, s[72:73]
    v_cndmask_b32 v148, v148, v152, s[72:73]
    v_cndmask_b32 v54, v54, v58, s[74:75]
    v_cndmask_b32 v102, v102, v106, s[74:75]
    v_cndmask_b32 v150, v150, v154, s[74:75]
    v_max_f32 v60, v52, v54
    v_max_f32 v108, v100, v102
    v_max_f32 v156, v148, v150
    v_mov_b32 v61, v60
    v_mov_b32 v109, v108
    v_mov_b32 v157, v156
    v_permlane32_swap_b32 v60, v61
    v_permlane32_swap_b32 v108, v109
    v_permlane32_swap_b32 v156, v157
    v_max_f32 v60, v60, v61
    v_max_f32 v108, v108, v109
    v_max_f32 v156, v156, v157
    v_mov_b32 v61, v60
    v_mov_b32 v109, v108
    v_mov_b32 v157, v156
    v_permlane16_swap_b32 v60, v61
    v_permlane16_swap_b32 v108, v109
    v_permlane16_swap_b32 v156, v157
    v_max_f32 v60, v60, v61
    v_max_f32 v108, v108, v109
    v_max_f32 v156, v156, v157
    v_mul_f32 v60, s45, v60
    v_mul_f32 v108, s45, v108
    v_mul_f32 v156, s45, v156
    v_fma_f32 v52, v52, s45, -v60
    v_fma_f32 v100, v100, s45, -v108
    v_fma_f32 v148, v148, s45, -v156
    v_fma_f32 v54, v54, s45, -v60
    v_fma_f32 v102, v102, s45, -v108
    v_fma_f32 v150, v150, s45, -v156
    v_exp_f32 v52, v52
    v_exp_f32 v100, v100
    v_exp_f32 v148, v148
    v_exp_f32 v54, v54
    v_exp_f32 v102, v102
    v_exp_f32 v150, v150
    v_add_f32 v60, v52, v54
    v_add_f32 v108, v100, v102
    v_add_f32 v156, v148, v150
    v_mov_b32 v61, v60
    v_mov_b32 v109, v108
    v_mov_b32 v157, v156
    v_permlane32_swap_b32 v60, v61
    v_permlane32_swap_b32 v108, v109
    v_permlane32_swap_b32 v156, v157
    v_add_f32 v60, v60, v61
    v_add_f32 v108, v108, v109
    v_add_f32 v156, v156, v157
    v_mov_b32 v61, v60
    v_mov_b32 v109, v108
    v_mov_b32 v157, v156
    v_permlane16_swap_b32 v60, v61
    v_permlane16_swap_b32 v108, v109
    v_permlane16_swap_b32 v156, v157
    v_add_f32 v60, v60, v61
    v_add_f32 v108, v108, v109
    v_add_f32 v156, v156, v157
    v_rcp_f32 v60, v60
    v_rcp_f32 v108, v108
    v_rcp_f32 v156, v156
    v_mul_f32 v52, v52, v60
    v_mul_f32 v100, v100, v108
    v_mul_f32 v148, v148, v156
    v_mul_f32 v54, v54, v60
    v_mul_f32 v102, v102, v108
    v_mul_f32 v150, v150, v156
    v_cvt_pk_bf16_f32 v52, v52, v52
    v_cvt_pk_bf16_f32 v100, v100, v100
    v_cvt_pk_bf16_f32 v148, v148, v148
    v_cvt_pk_bf16_f32 v54, v54, v54
    v_cvt_pk_bf16_f32 v102, v102, v102
    v_cvt_pk_bf16_f32 v150, v150, v150
    v_and_b32 v72, v240, v52
    v_and_b32 v120, v240, v100
    v_and_b32 v168, v240, v148
    v_and_b32 v73, v242, v54
    v_and_b32 v121, v242, v102
    v_and_b32 v169, v242, v150
    v_and_b32 v74, v241, v52
    v_and_b32 v122, v241, v100
    v_and_b32 v170, v241, v148
    v_and_b32 v75, v243, v54
    v_and_b32 v123, v243, v102
    v_and_b32 v171, v243, v150
    s_waitcnt lgkmcnt(0)
    v_mfma_f32_16x16x32_bf16 v[32:35], v[44:47], v[72:75], 0
    v_mfma_f32_16x16x32_bf16 v[36:39], v[48:51], v[72:75], 0
    v_mfma_f32_16x16x32_bf16 v[80:83], v[92:95], v[120:123], 0
    v_mfma_f32_16x16x32_bf16 v[84:87], v[96:99], v[120:123], 0
    v_mfma_f32_16x16x32_bf16 v[128:131], v[140:143], v[168:171], 0
    v_mfma_f32_16x16x32_bf16 v[132:135], v[144:147], v[168:171], 0
    s_nop 7
    v_cvt_pk_bf16_f32 v40, v32, v33
    v_cvt_pk_bf16_f32 v41, v34, v35
    v_cvt_pk_bf16_f32 v42, v36, v37
    v_cvt_pk_bf16_f32 v43, v38, v39
    ds_write_b64 v253, v[40:41]
    v_cvt_pk_bf16_f32 v88, v80, v81
    v_cvt_pk_bf16_f32 v89, v82, v83
    v_cvt_pk_bf16_f32 v90, v84, v85
    v_cvt_pk_bf16_f32 v91, v86, v87
    ds_write_b64 v118, v[88:89]
    v_cvt_pk_bf16_f32 v136, v128, v129
    v_cvt_pk_bf16_f32 v137, v130, v131
    v_cvt_pk_bf16_f32 v138, v132, v133
    v_cvt_pk_bf16_f32 v139, v134, v135
    ds_write_b64 v166, v[136:137]
    s_mov_b64 exec, 0xffff
    ds_write_b64 v253, v[42:43] offset:32
    ds_write_b64 v118, v[90:91] offset:32
    ds_write_b64 v166, v[138:139] offset:32
    s_mov_b64 exec, -1
    s_waitcnt lgkmcnt(0)
    s_barrier
    s_cmp_ge_u32 s3, 4
    s_cbranch_scc1 BLD_32
    v_readfirstlane_b32 s44, v250
    s_add_u32 s44, s44, 1
    s_barrier
    v_and_b32 v10, 15, v1
    v_lshrrev_b32 v11, 4, v1
    s_and_b32 s6, s3, 1
    s_mul_i32 s6, s6, 48
    v_add_u32 v10, s6, v10
    v_mul_u32_u24 v10, 80, v10
    v_add_u32 v12, 0, v11
    v_mul_u32_u24 v13, 52, v12
    v_lshrrev_b32 v13, 8, v13
    v_mul_u32_u24 v14, 5, v13
    v_sub_u32 v14, v12, v14
    v_mul_u32_u24 v13, 7680, v13
    v_lshlrev_b32 v14, 4, v14
    v_add3_u32 v224, v10, v13, v14
    v_add_u32 v12, 4, v11
    v_mul_u32_u24 v13, 52, v12
    v_lshrrev_b32 v13, 8, v13
    v_mul_u32_u24 v14, 5, v13
    v_sub_u32 v14, v12, v14
    v_mul_u32_u24 v13, 7680, v13
    v_lshlrev_b32 v14, 4, v14
    v_add3_u32 v225, v10, v13, v14
    v_add_u32 v12, 8, v11
    v_mul_u32_u24 v13, 52, v12
    v_lshrrev_b32 v13, 8, v13
    v_mul_u32_u24 v14, 5, v13
    v_sub_u32 v14, v12, v14
    v_mul_u32_u24 v13, 7680, v13
    v_lshlrev_b32 v14, 4, v14
    v_add3_u32 v226, v10, v13, v14
    v_add_u32 v12, 12, v11
    v_mul_u32_u24 v13, 52, v12
    v_lshrrev_b32 v13, 8, v13
    v_mul_u32_u24 v14, 5, v13
    v_sub_u32 v14, v12, v14
    v_mul_u32_u24 v13, 7680, v13
    v_lshlrev_b32 v14, 4, v14
    v_add3_u32 v227, v10, v13, v14
    v_add_u32 v12, 16, v11
    v_mul_u32_u24 v13, 52, v12
    v_lshrrev_b32 v13, 8, v13
    v_mul_u32_u24 v14, 5, v13
    v_sub_u32 v14, v12, v14
    v_mul_u32_u24 v13, 7680, v13
    v_lshlrev_b32 v14, 4, v14
    v_add3_u32 v228, v10, v13, v14
    v_lshrrev_b32 v12, 2, v1
    v_and_b32 v12, 3, v12
    v_lshlrev_b32 v13, 2, v11
    v_add_u32 v12, v12, v13
    v_mul_u32_u24 v12, 160, v12
    v_and_b32 v13, 3, v1
    v_lshlrev_b32 v13, 3, v13
    s_lshr_b32 s47, s3, 1
    s_mul_i32 s6, s47, 96
    v_add3_u32 v229, v12, v13, s6
    v_mov_b32 v16, 0
    v_mov_b32 v17, 0
    v_mov_b32 v18, 0
    v_mov_b32 v19, 0
    v_mov_b32 v20, 0
    v_mov_b32 v21, 0
    v_mov_b32 v22, 0
    v_mov_b32 v23, 0
    v_mov_b32 v24, 0
    v_mov_b32 v25, 0
    v_mov_b32 v26, 0
    v_mov_b32 v27, 0
    v_mov_b32 v28, 0
    v_mov_b32 v29, 0
    v_mov_b32 v30, 0
    v_mov_b32 v31, 0
    v_mov_b32 v32, 0
    v_mov_b32 v33, 0
    v_mov_b32 v34, 0
    v_mov_b32 v35, 0
    v_mov_b32 v36, 0
    v_mov_b32 v37, 0
    v_mov_b32 v38, 0
    v_mov_b32 v39, 0
    v_mov_b32 v40, 0
    v_mov_b32 v41, 0
    v_mov_b32 v42, 0
    v_mov_b32 v43, 0
    v_mov_b32 v44, 0
    v_mov_b32 v45, 0
    v_mov_b32 v46, 0
    v_mov_b32 v47, 0
    v_mov_b32 v48, 0
    v_mov_b32 v49, 0
    v_mov_b32 v50, 0
    v_mov_b32 v51, 0
    s_mov_b32 s56, s26
    s_mov_b32 s57, s27
    s_mov_b32 s58, 0x500000
    s_mov_b32 s59, 0x00020000
    v_and_b32 v13, 15, v1
    s_and_b32 s6, s3, 1
    s_mul_i32 s6, s6, 48
    s_mul_i32 s7, s67, 96
    s_add_u32 s6, s6, s7
    v_add_u32 v13, s6, v13
    v_mul_u32_u24 v13, 2560, v13
    v_lshrrev_b32 v14, 4, v1
    v_lshlrev_b32 v14, 3, v14
    s_mul_i32 s6, s68, 160
    s_mul_i32 s7, s47, 96
    s_add_u32 s6, s6, s7
    s_add_u32 s6, s6, 1280
    v_add3_u32 v213, v13, v14, s6
    s_mov_b32 s72, 0
    s_mov_b32 s73, 40960
    s_mov_b32 s74, 81920
    s_barrier
    s_cmp_lg_u32 s3, 0
    s_cbranch_scc1 NP_34
    s_lshl_b32 s6, s60, 4
    s_add_u32 s6, s6, s61
    s_lshl_b32 s6, s6, 7
    v_mov_b32 v10, s6
    v_mov_b32 v11, s44
    s_mov_b64 exec, 1
    buffer_store_dword v11, v10, s[52:55], 0 offen sc1
    s_mov_b64 exec, -1
    s_lshl_b32 s6, s60, 11
    v_lshlrev_b32 v10, 7, v1
    v_add_u32 v10, s6, v10
    s_mov_b32 s45, 0
    s_mov_b64 exec, 0xffff
PF_35:
    buffer_load_dword v4, v10, s[52:55], 0 offen sc1
    s_waitcnt vmcnt(0)
    v_cmp_ne_u32 vcc, s44, v4
    s_add_u32 s45, s45, 1
    s_nop 3
    s_cbranch_vccz PF_36
    s_cmp_gt_u32 s45, 1048576
    s_cbranch_scc1 PF_36
    s_sleep 2
    s_branch PF_35
PF_36:
    s_mov_b64 exec, -1
    s_cmp_lg_u32 s61, 0
    s_cbranch_scc1 EU_37
    v_mov_b32 v11, s44
    s_mov_b64 exec, 1
    buffer_store_dword v11, v251, s[52:55], 0 offen sc1
    s_mov_b64 exec, -1
EU_37:
NP_34:
    s_barrier
    v_add_u32 v192, 40960, v224
    v_add_u32 v202, 102400, v229
    v_add_u32 v193, 40960, v225
    v_add_u32 v203, 107520, v229
    v_add_u32 v194, 40960, v226
    v_add_u32 v204, 112640, v229
    v_add_u32 v195, 40960, v227
    v_add_u32 v205, 117760, v229
    v_add_u32 v196, 40960, v228
    v_add_u32 v206, 122880, v229
    s_cmp_eq_u32 s47, 0
    s_cbranch_scc0 C2E_38
    ds_read_b64_tr_b16 v[56:57], v202 offset:0
    ds_read_b64_tr_b16 v[58:59], v202 offset:2560
    ds_read_b64_tr_b16 v[60:61], v202 offset:32
    ds_read_b64_tr_b16 v[62:63], v202 offset:2592
    ds_read_b64_tr_b16 v[64:65], v202 offset:64
    ds_read_b64_tr_b16 v[66:67], v202 offset:2624
    ds_read_b64_tr_b16 v[68:69], v203 offset:0
    ds_read_b64_tr_b16 v[70:71], v203 offset:2560
    ds_read_b64_tr_b16 v[72:73], v203 offset:32
    ds_read_b64_tr_b16 v[74:75], v203 offset:2592
    ds_read_b64_tr_b16 v[76:77], v203 offset:64
    ds_read_b64_tr_b16 v[78:79], v203 offset:2624
    ds_read_b64_tr_b16 v[80:81], v204 offset:0
    ds_read_b64_tr_b16 v[82:83], v204 offset:2560
    ds_read_b64_tr_b16 v[84:85], v204 offset:32
    ds_read_b64_tr_b16 v[86:87], v204 offset:2592
    ds_read_b64_tr_b16 v[88:89], v204 offset:64
    ds_read_b64_tr_b16 v[90:91], v204 offset:2624
    ds_read_b64_tr_b16 v[92:93], v205 offset:0
    ds_read_b64_tr_b16 v[94:95], v205 offset:2560
    ds_read_b64_tr_b16 v[96:97], v205 offset:32
    ds_read_b64_tr_b16 v[98:99], v205 offset:2592
    ds_read_b64_tr_b16 v[100:101], v205 offset:64
    ds_read_b64_tr_b16 v[102:103], v205 offset:2624
    ds_read_b64_tr_b16 v[104:105], v206 offset:0
    ds_read_b64_tr_b16 v[106:107], v206 offset:2560
    ds_read_b64_tr_b16 v[108:109], v206 offset:32
    ds_read_b64_tr_b16 v[110:111], v206 offset:2592
    ds_read_b64_tr_b16 v[112:113], v206 offset:64
    ds_read_b64_tr_b16 v[114:115], v206 offset:2624
    s_waitcnt lgkmcnt(0)
    s_barrier
    ds_read_b128 v[120:123], v192 offset:0
    ds_read_b128 v[124:127], v192 offset:1280
    ds_read_b128 v[128:131], v192 offset:2560
    s_waitcnt lgkmcnt(0)
    v_mfma_f32_16x16x32_bf16 v[16:19], v[56:59], v[120:123], v[16:19]
    ds_read_b128 v[132:135], v193 offset:0
    ds_read_b128 v[136:139], v193 offset:1280
    ds_read_b128 v[140:143], v193 offset:2560
    v_mfma_f32_16x16x32_bf16 v[20:23], v[60:63], v[120:123], v[20:23]
    ds_read_b128 v[144:147], v194 offset:0
    ds_read_b128 v[148:151], v194 offset:1280
    ds_read_b128 v[152:155], v194 offset:2560
    v_mfma_f32_16x16x32_bf16 v[24:27], v[64:67], v[120:123], v[24:27]
    ds_read_b128 v[156:159], v195 offset:0
    ds_read_b128 v[160:163], v195 offset:1280
    ds_read_b128 v[164:167], v195 offset:2560
    v_mfma_f32_16x16x32_bf16 v[28:31], v[56:59], v[124:127], v[28:31]
    ds_read_b128 v[168:171], v196 offset:0
    ds_read_b128 v[172:175], v196 offset:1280
    ds_read_b128 v[176:179], v196 offset:2560
    v_mfma_f32_16x16x32_bf16 v[32:35], v[60:63], v[124:127], v[32:35]
    v_add_u32 v197, 71680, v224
    v_add_u32 v207, 133120, v229
    v_add_u32 v198, 71680, v225
    v_mfma_f32_16x16x32_bf16 v[36:39], v[64:67], v[124:127], v[36:39]
    v_add_u32 v208, 138240, v229
    v_add_u32 v199, 71680, v226
    v_add_u32 v209, 143360, v229
    v_mfma_f32_16x16x32_bf16 v[40:43], v[56:59], v[128:131], v[40:43]
    v_add_u32 v200, 71680, v227
    v_add_u32 v210, 148480, v229
    v_add_u32 v201, 71680, v228
    v_mfma_f32_16x16x32_bf16 v[44:47], v[60:63], v[128:131], v[44:47]
    v_add_u32 v211, 153600, v229
    v_mfma_f32_16x16x32_bf16 v[48:51], v[64:67], v[128:131], v[48:51]
    s_waitcnt lgkmcnt(9)
    v_mfma_f32_16x16x32_bf16 v[16:19], v[68:71], v[132:135], v[16:19]
    ds_read_b64_tr_b16 v[56:57], v207 offset:0
    v_mfma_f32_16x16x32_bf16 v[20:23], v[72:75], v[132:135], v[20:23]
    ds_read_b64_tr_b16 v[58:59], v207 offset:2560
    v_mfma_f32_16x16x32_bf16 v[24:27], v[76:79], v[132:135], v[24:27]
    ds_read_b64_tr_b16 v[60:61], v207 offset:32
    v_mfma_f32_16x16x32_bf16 v[28:31], v[68:71], v[136:139], v[28:31]
    ds_read_b64_tr_b16 v[62:63], v207 offset:2592
    v_mfma_f32_16x16x32_bf16 v[32:35], v[72:75], v[136:139], v[32:35]
    ds_read_b64_tr_b16 v[64:65], v207 offset:64
    v_mfma_f32_16x16x32_bf16 v[36:39], v[76:79], v[136:139], v[36:39]
    ds_read_b64_tr_b16 v[66:67], v207 offset:2624
    v_mfma_f32_16x16x32_bf16 v[40:43], v[68:71], v[140:143], v[40:43]
    v_mfma_f32_16x16x32_bf16 v[44:47], v[72:75], v[140:143], v[44:47]
    v_mfma_f32_16x16x32_bf16 v[48:51], v[76:79], v[140:143], v[48:51]
    s_waitcnt lgkmcnt(12)
    v_mfma_f32_16x16x32_bf16 v[16:19], v[80:83], v[144:147], v[16:19]
    ds_read_b64_tr_b16 v[68:69], v208 offset:0
    v_mfma_f32_16x16x32_bf16 v[20:23], v[84:87], v[144:147], v[20:23]
    ds_read_b64_tr_b16 v[70:71], v208 offset:2560
    v_mfma_f32_16x16x32_bf16 v[24:27], v[88:91], v[144:147], v[24:27]
    ds_read_b64_tr_b16 v[72:73], v208 offset:32
    v_mfma_f32_16x16x32_bf16 v[28:31], v[80:83], v[148:151], v[28:31]
    ds_read_b64_tr_b16 v[74:75], v208 offset:2592
    v_mfma_f32_16x16x32_bf16 v[32:35], v[84:87], v[148:151], v[32:35]
    ds_read_b64_tr_b16 v[76:77], v208 offset:64
    v_mfma_f32_16x16x32_bf16 v[36:39], v[88:91], v[148:151], v[36:39]
    ds_read_b64_tr_b16 v[78:79], v208 offset:2624
    v_mfma_f32_16x16x32_bf16 v[40:43], v[80:83], v[152:155], v[40:43]
    v_mfma_f32_16x16x32_bf16 v[44:47], v[84:87], v[152:155], v[44:47]
    v_mfma_f32_16x16x32_bf16 v[48:51], v[88:91], v[152:155], v[48:51]
    s_waitcnt lgkmcnt(15)
    v_mfma_f32_16x16x32_bf16 v[16:19], v[92:95], v[156:159], v[16:19]
    ds_read_b64_tr_b16 v[80:81], v209 offset:0
    v_mfma_f32_16x16x32_bf16 v[20:23], v[96:99], v[156:159], v[20:23]
    ds_read_b64_tr_b16 v[82:83], v209 offset:2560
    v_mfma_f32_16x16x32_bf16 v[24:27], v[100:103], v[156:159], v[24:27]
    ds_read_b64_tr_b16 v[84:85], v209 offset:32
    v_mfma_f32_16x16x32_bf16 v[28:31], v[92:95], v[160:163], v[28:31]
    ds_read_b64_tr_b16 v[86:87], v209 offset:2592
    v_mfma_f32_16x16x32_bf16 v[32:35], v[96:99], v[160:163], v[32:35]
    ds_read_b64_tr_b16 v[88:89], v209 offset:64
    v_mfma_f32_16x16x32_bf16 v[36:39], v[100:103], v[160:163], v[36:39]
    ds_read_b64_tr_b16 v[90:91], v209 offset:2624
    v_mfma_f32_16x16x32_bf16 v[40:43], v[92:95], v[164:167], v[40:43]
    v_mfma_f32_16x16x32_bf16 v[44:47], v[96:99], v[164:167], v[44:47]
    v_mfma_f32_16x16x32_bf16 v[48:51], v[100:103], v[164:167], v[48:51]
    s_waitcnt lgkmcnt(15)
    s_barrier
    ds_read_b128 v[120:123], v197 offset:0
    ds_read_b128 v[124:127], v197 offset:1280
    ds_read_b128 v[128:131], v197 offset:2560
    v_mfma_f32_16x16x32_bf16 v[16:19], v[104:107], v[168:171], v[16:19]
    ds_read_b64_tr_b16 v[92:93], v210 offset:0
    v_mfma_f32_16x16x32_bf16 v[20:23], v[108:111], v[168:171], v[20:23]
    ds_read_b64_tr_b16 v[94:95], v210 offset:2560
    v_mfma_f32_16x16x32_bf16 v[24:27], v[112:115], v[168:171], v[24:27]
    ds_read_b64_tr_b16 v[96:97], v210 offset:32
    v_mfma_f32_16x16x32_bf16 v[28:31], v[104:107], v[172:175], v[28:31]
    ds_read_b64_tr_b16 v[98:99], v210 offset:2592
    v_mfma_f32_16x16x32_bf16 v[32:35], v[108:111], v[172:175], v[32:35]
    ds_read_b64_tr_b16 v[100:101], v210 offset:64
    v_mfma_f32_16x16x32_bf16 v[36:39], v[112:115], v[172:175], v[36:39]
    ds_read_b64_tr_b16 v[102:103], v210 offset:2624
    v_mfma_f32_16x16x32_bf16 v[40:43], v[104:107], v[176:179], v[40:43]
    v_mfma_f32_16x16x32_bf16 v[44:47], v[108:111], v[176:179], v[44:47]
    v_mfma_f32_16x16x32_bf16 v[48:51], v[112:115], v[176:179], v[48:51]
    s_waitcnt lgkmcnt(0)
    v_mfma_f32_16x16x32_bf16 v[16:19], v[56:59], v[120:123], v[16:19]
    ds_read_b64_tr_b16 v[104:105], v211 offset:0
    ds_read_b64_tr_b16 v[106:107], v211 offset:2560
    ds_read_b64_tr_b16 v[108:109], v211 offset:32
    ds_read_b64_tr_b16 v[110:111], v211 offset:2592
    v_mfma_f32_16x16x32_bf16 v[20:23], v[60:63], v[120:123], v[20:23]
    ds_read_b64_tr_b16 v[112:113], v211 offset:64
    ds_read_b64_tr_b16 v[114:115], v211 offset:2624
    ds_read_b128 v[132:135], v198 offset:0
    ds_read_b128 v[136:139], v198 offset:1280
    v_mfma_f32_16x16x32_bf16 v[24:27], v[64:67], v[120:123], v[24:27]
    ds_read_b128 v[140:143], v198 offset:2560
    ds_read_b128 v[144:147], v199 offset:0
    ds_read_b128 v[148:151], v199 offset:1280
    ds_read_b128 v[152:155], v199 offset:2560
    v_mfma_f32_16x16x32_bf16 v[28:31], v[56:59], v[124:127], v[28:31]
    ds_read_b128 v[156:159], v200 offset:0
    ds_read_b128 v[160:163], v200 offset:1280
    ds_read_b128 v[164:167], v200 offset:2560
    ds_read_b128 v[168:171], v201 offset:0
    v_mfma_f32_16x16x32_bf16 v[32:35], v[60:63], v[124:127], v[32:35]
    ds_read_b128 v[172:175], v201 offset:1280
    ds_read_b128 v[176:179], v201 offset:2560
    v_add_u32 v192, 102400, v224
    v_add_u32 v202, 158720, v229
    v_mfma_f32_16x16x32_bf16 v[36:39], v[64:67], v[124:127], v[36:39]
    v_add_u32 v193, 102400, v225
    v_add_u32 v203, 0, v229
    v_add_u32 v194, 102400, v226
    v_add_u32 v204, 5120, v229
    v_mfma_f32_16x16x32_bf16 v[40:43], v[56:59], v[128:131], v[40:43]
    v_add_u32 v195, 102400, v227
    v_add_u32 v205, 10240, v229
    v_add_u32 v196, 102400, v228
    v_add_u32 v206, 15360, v229
    v_mfma_f32_16x16x32_bf16 v[44:47], v[60:63], v[128:131], v[44:47]
    v_mfma_f32_16x16x32_bf16 v[48:51], v[64:67], v[128:131], v[48:51]
    s_waitcnt lgkmcnt(9)
    v_mfma_f32_16x16x32_bf16 v[16:19], v[68:71], v[132:135], v[16:19]
    ds_read_b64_tr_b16 v[56:57], v202 offset:0
    v_mfma_f32_16x16x32_bf16 v[20:23], v[72:75], v[132:135], v[20:23]
    ds_read_b64_tr_b16 v[58:59], v202 offset:2560
    v_mfma_f32_16x16x32_bf16 v[24:27], v[76:79], v[132:135], v[24:27]
    ds_read_b64_tr_b16 v[60:61], v202 offset:32
    v_mfma_f32_16x16x32_bf16 v[28:31], v[68:71], v[136:139], v[28:31]
    ds_read_b64_tr_b16 v[62:63], v202 offset:2592
    v_mfma_f32_16x16x32_bf16 v[32:35], v[72:75], v[136:139], v[32:35]
    ds_read_b64_tr_b16 v[64:65], v202 offset:64
    v_mfma_f32_16x16x32_bf16 v[36:39], v[76:79], v[136:139], v[36:39]
    ds_read_b64_tr_b16 v[66:67], v202 offset:2624
    v_mfma_f32_16x16x32_bf16 v[40:43], v[68:71], v[140:143], v[40:43]
    v_mfma_f32_16x16x32_bf16 v[44:47], v[72:75], v[140:143], v[44:47]
    v_mfma_f32_16x16x32_bf16 v[48:51], v[76:79], v[140:143], v[48:51]
    s_waitcnt lgkmcnt(12)
    v_mfma_f32_16x16x32_bf16 v[16:19], v[80:83], v[144:147], v[16:19]
    ds_read_b64_tr_b16 v[68:69], v203 offset:0
    v_mfma_f32_16x16x32_bf16 v[20:23], v[84:87], v[144:147], v[20:23]
    ds_read_b64_tr_b16 v[70:71], v203 offset:2560
    v_mfma_f32_16x16x32_bf16 v[24:27], v[88:91], v[144:147], v[24:27]
    ds_read_b64_tr_b16 v[72:73], v203 offset:32
    v_mfma_f32_16x16x32_bf16 v[28:31], v[80:83], v[148:151], v[28:31]
    ds_read_b64_tr_b16 v[74:75], v203 offset:2592
    v_mfma_f32_16x16x32_bf16 v[32:35], v[84:87], v[148:151], v[32:35]
    ds_read_b64_tr_b16 v[76:77], v203 offset:64
    v_mfma_f32_16x16x32_bf16 v[36:39], v[88:91], v[148:151], v[36:39]
    ds_read_b64_tr_b16 v[78:79], v203 offset:2624
    v_mfma_f32_16x16x32_bf16 v[40:43], v[80:83], v[152:155], v[40:43]
    v_mfma_f32_16x16x32_bf16 v[44:47], v[84:87], v[152:155], v[44:47]
    v_mfma_f32_16x16x32_bf16 v[48:51], v[88:91], v[152:155], v[48:51]
    s_waitcnt lgkmcnt(15)
    v_mfma_f32_16x16x32_bf16 v[16:19], v[92:95], v[156:159], v[16:19]
    ds_read_b64_tr_b16 v[80:81], v204 offset:0
    v_mfma_f32_16x16x32_bf16 v[20:23], v[96:99], v[156:159], v[20:23]
    ds_read_b64_tr_b16 v[82:83], v204 offset:2560
    v_mfma_f32_16x16x32_bf16 v[24:27], v[100:103], v[156:159], v[24:27]
    ds_read_b64_tr_b16 v[84:85], v204 offset:32
    v_mfma_f32_16x16x32_bf16 v[28:31], v[92:95], v[160:163], v[28:31]
    ds_read_b64_tr_b16 v[86:87], v204 offset:2592
    v_mfma_f32_16x16x32_bf16 v[32:35], v[96:99], v[160:163], v[32:35]
    ds_read_b64_tr_b16 v[88:89], v204 offset:64
    v_mfma_f32_16x16x32_bf16 v[36:39], v[100:103], v[160:163], v[36:39]
    ds_read_b64_tr_b16 v[90:91], v204 offset:2624
    v_mfma_f32_16x16x32_bf16 v[40:43], v[92:95], v[164:167], v[40:43]
    v_mfma_f32_16x16x32_bf16 v[44:47], v[96:99], v[164:167], v[44:47]
    v_mfma_f32_16x16x32_bf16 v[48:51], v[100:103], v[164:167], v[48:51]
    s_waitcnt lgkmcnt(15)
    s_barrier
    ds_read_b128 v[120:123], v192 offset:0
    ds_read_b128 v[124:127], v192 offset:1280
    ds_read_b128 v[128:131], v192 offset:2560
    v_mfma_f32_16x16x32_bf16 v[16:19], v[104:107], v[168:171], v[16:19]
    ds_read_b64_tr_b16 v[92:93], v205 offset:0
    v_mfma_f32_16x16x32_bf16 v[20:23], v[108:111], v[168:171], v[20:23]
    ds_read_b64_tr_b16 v[94:95], v205 offset:2560
    v_mfma_f32_16x16x32_bf16 v[24:27], v[112:115], v[168:171], v[24:27]
    ds_read_b64_tr_b16 v[96:97], v205 offset:32
    v_mfma_f32_16x16x32_bf16 v[28:31], v[104:107], v[172:175], v[28:31]
    ds_read_b64_tr_b16 v[98:99], v205 offset:2592
    v_mfma_f32_16x16x32_bf16 v[32:35], v[108:111], v[172:175], v[32:35]
    ds_read_b64_tr_b16 v[100:101], v205 offset:64
    v_mfma_f32_16x16x32_bf16 v[36:39], v[112:115], v[172:175], v[36:39]
    ds_read_b64_tr_b16 v[102:103], v205 offset:2624
    v_mfma_f32_16x16x32_bf16 v[40:43], v[104:107], v[176:179], v[40:43]
    v_mfma_f32_16x16x32_bf16 v[44:47], v[108:111], v[176:179], v[44:47]
    v_mfma_f32_16x16x32_bf16 v[48:51], v[112:115], v[176:179], v[48:51]
    s_waitcnt lgkmcnt(0)
    v_mfma_f32_16x16x32_bf16 v[16:19], v[56:59], v[120:123], v[16:19]
    ds_read_b64_tr_b16 v[104:105], v206 offset:0
    ds_read_b64_tr_b16 v[106:107], v206 offset:2560
    ds_read_b64_tr_b16 v[108:109], v206 offset:32
    ds_read_b64_tr_b16 v[110:111], v206 offset:2592
    v_mfma_f32_16x16x32_bf16 v[20:23], v[60:63], v[120:123], v[20:23]
    ds_read_b64_tr_b16 v[112:113], v206 offset:64
    ds_read_b64_tr_b16 v[114:115], v206 offset:2624
    ds_read_b128 v[132:135], v193 offset:0
    ds_read_b128 v[136:139], v193 offset:1280
    v_mfma_f32_16x16x32_bf16 v[24:27], v[64:67], v[120:123], v[24:27]
    ds_read_b128 v[140:143], v193 offset:2560
    ds_read_b128 v[144:147], v194 offset:0
    ds_read_b128 v[148:151], v194 offset:1280
    ds_read_b128 v[152:155], v194 offset:2560
    v_mfma_f32_16x16x32_bf16 v[28:31], v[56:59], v[124:127], v[28:31]
    ds_read_b128 v[156:159], v195 offset:0
    ds_read_b128 v[160:163], v195 offset:1280
    ds_read_b128 v[164:167], v195 offset:2560
    ds_read_b128 v[168:171], v196 offset:0
    v_mfma_f32_16x16x32_bf16 v[32:35], v[60:63], v[124:127], v[32:35]
    ds_read_b128 v[172:175], v196 offset:1280
    ds_read_b128 v[176:179], v196 offset:2560
    v_add_u32 v197, 40960, v224
    v_add_u32 v207, 20480, v229
    v_mfma_f32_16x16x32_bf16 v[36:39], v[64:67], v[124:127], v[36:39]
    v_add_u32 v198, 40960, v225
    v_add_u32 v208, 25600, v229
    v_add_u32 v199, 40960, v226
    v_add_u32 v209, 30720, v229
    v_mfma_f32_16x16x32_bf16 v[40:43], v[56:59], v[128:131], v[40:43]
    v_add_u32 v200, 40960, v227
    v_add_u32 v210, 35840, v229
    v_add_u32 v201, 40960, v228
    v_add_u32 v211, 133120, v229
    v_mfma_f32_16x16x32_bf16 v[44:47], v[60:63], v[128:131], v[44:47]
    v_mfma_f32_16x16x32_bf16 v[48:51], v[64:67], v[128:131], v[48:51]
    s_waitcnt lgkmcnt(9)
    v_mfma_f32_16x16x32_bf16 v[16:19], v[68:71], v[132:135], v[16:19]
    ds_read_b64_tr_b16 v[56:57], v207 offset:0
    v_mfma_f32_16x16x32_bf16 v[20:23], v[72:75], v[132:135], v[20:23]
    ds_read_b64_tr_b16 v[58:59], v207 offset:2560
    v_mfma_f32_16x16x32_bf16 v[24:27], v[76:79], v[132:135], v[24:27]
    ds_read_b64_tr_b16 v[60:61], v207 offset:32
    v_mfma_f32_16x16x32_bf16 v[28:31], v[68:71], v[136:139], v[28:31]
    ds_read_b64_tr_b16 v[62:63], v207 offset:2592
    v_mfma_f32_16x16x32_bf16 v[32:35], v[72:75], v[136:139], v[32:35]
    ds_read_b64_tr_b16 v[64:65], v207 offset:64
    v_mfma_f32_16x16x32_bf16 v[36:39], v[76:79], v[136:139], v[36:39]
    ds_read_b64_tr_b16 v[66:67], v207 offset:2624
    v_mfma_f32_16x16x32_bf16 v[40:43], v[68:71], v[140:143], v[40:43]
    v_mfma_f32_16x16x32_bf16 v[44:47], v[72:75], v[140:143], v[44:47]
    v_mfma_f32_16x16x32_bf16 v[48:51], v[76:79], v[140:143], v[48:51]
    s_waitcnt lgkmcnt(12)
    v_mfma_f32_16x16x32_bf16 v[16:19], v[80:83], v[144:147], v[16:19]
    ds_read_b64_tr_b16 v[68:69], v208 offset:0
    v_mfma_f32_16x16x32_bf16 v[20:23], v[84:87], v[144:147], v[20:23]
    ds_read_b64_tr_b16 v[70:71], v208 offset:2560
    v_mfma_f32_16x16x32_bf16 v[24:27], v[88:91], v[144:147], v[24:27]
    ds_read_b64_tr_b16 v[72:73], v208 offset:32
    v_mfma_f32_16x16x32_bf16 v[28:31], v[80:83], v[148:151], v[28:31]
    ds_read_b64_tr_b16 v[74:75], v208 offset:2592
    v_mfma_f32_16x16x32_bf16 v[32:35], v[84:87], v[148:151], v[32:35]
    ds_read_b64_tr_b16 v[76:77], v208 offset:64
    v_mfma_f32_16x16x32_bf16 v[36:39], v[88:91], v[148:151], v[36:39]
    ds_read_b64_tr_b16 v[78:79], v208 offset:2624
    v_mfma_f32_16x16x32_bf16 v[40:43], v[80:83], v[152:155], v[40:43]
    v_mfma_f32_16x16x32_bf16 v[44:47], v[84:87], v[152:155], v[44:47]
    v_mfma_f32_16x16x32_bf16 v[48:51], v[88:91], v[152:155], v[48:51]
    s_waitcnt lgkmcnt(15)
    v_mfma_f32_16x16x32_bf16 v[16:19], v[92:95], v[156:159], v[16:19]
    ds_read_b64_tr_b16 v[80:81], v209 offset:0
    v_mfma_f32_16x16x32_bf16 v[20:23], v[96:99], v[156:159], v[20:23]
    ds_read_b64_tr_b16 v[82:83], v209 offset:2560
    v_mfma_f32_16x16x32_bf16 v[24:27], v[100:103], v[156:159], v[24:27]
    ds_read_b64_tr_b16 v[84:85], v209 offset:32
    v_mfma_f32_16x16x32_bf16 v[28:31], v[92:95], v[160:163], v[28:31]
    ds_read_b64_tr_b16 v[86:87], v209 offset:2592
    v_mfma_f32_16x16x32_bf16 v[32:35], v[96:99], v[160:163], v[32:35]
    ds_read_b64_tr_b16 v[88:89], v209 offset:64
    v_mfma_f32_16x16x32_bf16 v[36:39], v[100:103], v[160:163], v[36:39]
    ds_read_b64_tr_b16 v[90:91], v209 offset:2624
    v_mfma_f32_16x16x32_bf16 v[40:43], v[92:95], v[164:167], v[40:43]
    v_mfma_f32_16x16x32_bf16 v[44:47], v[96:99], v[164:167], v[44:47]
    v_mfma_f32_16x16x32_bf16 v[48:51], v[100:103], v[164:167], v[48:51]
    s_waitcnt lgkmcnt(15)
    s_barrier
    ds_read_b128 v[120:123], v197 offset:0
    ds_read_b128 v[124:127], v197 offset:1280
    ds_read_b128 v[128:131], v197 offset:2560
    v_mfma_f32_16x16x32_bf16 v[16:19], v[104:107], v[168:171], v[16:19]
    ds_read_b64_tr_b16 v[92:93], v210 offset:0
    v_mfma_f32_16x16x32_bf16 v[20:23], v[108:111], v[168:171], v[20:23]
    ds_read_b64_tr_b16 v[94:95], v210 offset:2560
    v_mfma_f32_16x16x32_bf16 v[24:27], v[112:115], v[168:171], v[24:27]
    ds_read_b64_tr_b16 v[96:97], v210 offset:32
    v_mfma_f32_16x16x32_bf16 v[28:31], v[104:107], v[172:175], v[28:31]
    ds_read_b64_tr_b16 v[98:99], v210 offset:2592
    v_mfma_f32_16x16x32_bf16 v[32:35], v[108:111], v[172:175], v[32:35]
    ds_read_b64_tr_b16 v[100:101], v210 offset:64
    v_mfma_f32_16x16x32_bf16 v[36:39], v[112:115], v[172:175], v[36:39]
    ds_read_b64_tr_b16 v[102:103], v210 offset:2624
    v_mfma_f32_16x16x32_bf16 v[40:43], v[104:107], v[176:179], v[40:43]
    v_mfma_f32_16x16x32_bf16 v[44:47], v[108:111], v[176:179], v[44:47]
    v_mfma_f32_16x16x32_bf16 v[48:51], v[112:115], v[176:179], v[48:51]
    s_waitcnt lgkmcnt(0)
    v_mfma_f32_16x16x32_bf16 v[16:19], v[56:59], v[120:123], v[16:19]
    ds_read_b64_tr_b16 v[104:105], v211 offset:0
    ds_read_b64_tr_b16 v[106:107], v211 offset:2560
    v_mfma_f32_16x16x32_bf16 v[20:23], v[60:63], v[120:123], v[20:23]
    ds_read_b64_tr_b16 v[108:109], v211 offset:32
    ds_read_b64_tr_b16 v[110:111], v211 offset:2592
    v_mfma_f32_16x16x32_bf16 v[24:27], v[64:67], v[120:123], v[24:27]
    ds_read_b64_tr_b16 v[112:113], v211 offset:64
    ds_read_b64_tr_b16 v[114:115], v211 offset:2624
    v_mfma_f32_16x16x32_bf16 v[28:31], v[56:59], v[124:127], v[28:31]
    ds_read_b128 v[132:135], v198 offset:0
    ds_read_b128 v[136:139], v198 offset:1280
    v_mfma_f32_16x16x32_bf16 v[32:35], v[60:63], v[124:127], v[32:35]
    ds_read_b128 v[140:143], v198 offset:2560
    ds_read_b128 v[144:147], v199 offset:0
    v_mfma_f32_16x16x32_bf16 v[36:39], v[64:67], v[124:127], v[36:39]
    ds_read_b128 v[148:151], v199 offset:1280
    ds_read_b128 v[152:155], v199 offset:2560
    v_mfma_f32_16x16x32_bf16 v[40:43], v[56:59], v[128:131], v[40:43]
    ds_read_b128 v[156:159], v200 offset:0
    ds_read_b128 v[160:163], v200 offset:1280
    v_mfma_f32_16x16x32_bf16 v[44:47], v[60:63], v[128:131], v[44:47]
    ds_read_b128 v[164:167], v200 offset:2560
    ds_read_b128 v[168:171], v201 offset:0
    v_mfma_f32_16x16x32_bf16 v[48:51], v[64:67], v[128:131], v[48:51]
    ds_read_b128 v[172:175], v201 offset:1280
    ds_read_b128 v[176:179], v201 offset:2560
    s_waitcnt lgkmcnt(9)
    v_mfma_f32_16x16x32_bf16 v[16:19], v[68:71], v[132:135], v[16:19]
    v_mfma_f32_16x16x32_bf16 v[20:23], v[72:75], v[132:135], v[20:23]
    v_mfma_f32_16x16x32_bf16 v[24:27], v[76:79], v[132:135], v[24:27]
    v_mfma_f32_16x16x32_bf16 v[28:31], v[68:71], v[136:139], v[28:31]
    v_mfma_f32_16x16x32_bf16 v[32:35], v[72:75], v[136:139], v[32:35]
    v_mfma_f32_16x16x32_bf16 v[36:39], v[76:79], v[136:139], v[36:39]
    v_mfma_f32_16x16x32_bf16 v[40:43], v[68:71], v[140:143], v[40:43]
    v_mfma_f32_16x16x32_bf16 v[44:47], v[72:75], v[140:143], v[44:47]
    v_mfma_f32_16x16x32_bf16 v[48:51], v[76:79], v[140:143], v[48:51]
    s_waitcnt lgkmcnt(6)
    v_mfma_f32_16x16x32_bf16 v[16:19], v[80:83], v[144:147], v[16:19]
    v_mfma_f32_16x16x32_bf16 v[20:23], v[84:87], v[144:147], v[20:23]
    v_mfma_f32_16x16x32_bf16 v[24:27], v[88:91], v[144:147], v[24:27]
    v_mfma_f32_16x16x32_bf16 v[28:31], v[80:83], v[148:151], v[28:31]
    v_mfma_f32_16x16x32_bf16 v[32:35], v[84:87], v[148:151], v[32:35]
    v_mfma_f32_16x16x32_bf16 v[36:39], v[88:91], v[148:151], v[36:39]
    v_mfma_f32_16x16x32_bf16 v[40:43], v[80:83], v[152:155], v[40:43]
    v_mfma_f32_16x16x32_bf16 v[44:47], v[84:87], v[152:155], v[44:47]
    v_mfma_f32_16x16x32_bf16 v[48:51], v[88:91], v[152:155], v[48:51]
    s_waitcnt lgkmcnt(3)
    v_mfma_f32_16x16x32_bf16 v[16:19], v[92:95], v[156:159], v[16:19]
    v_mfma_f32_16x16x32_bf16 v[20:23], v[96:99], v[156:159], v[20:23]
    v_mfma_f32_16x16x32_bf16 v[24:27], v[100:103], v[156:159], v[24:27]
    v_mfma_f32_16x16x32_bf16 v[28:31], v[92:95], v[160:163], v[28:31]
    v_mfma_f32_16x16x32_bf16 v[32:35], v[96:99], v[160:163], v[32:35]
    v_mfma_f32_16x16x32_bf16 v[36:39], v[100:103], v[160:163], v[36:39]
    v_mfma_f32_16x16x32_bf16 v[40:43], v[92:95], v[164:167], v[40:43]
    v_mfma_f32_16x16x32_bf16 v[44:47], v[96:99], v[164:167], v[44:47]
    v_mfma_f32_16x16x32_bf16 v[48:51], v[100:103], v[164:167], v[48:51]
    s_waitcnt lgkmcnt(0)
    v_mfma_f32_16x16x32_bf16 v[16:19], v[104:107], v[168:171], v[16:19]
    v_mfma_f32_16x16x32_bf16 v[20:23], v[108:111], v[168:171], v[20:23]
    v_mfma_f32_16x16x32_bf16 v[24:27], v[112:115], v[168:171], v[24:27]
    v_mfma_f32_16x16x32_bf16 v[28:31], v[104:107], v[172:175], v[28:31]
    v_mfma_f32_16x16x32_bf16 v[32:35], v[108:111], v[172:175], v[32:35]
    v_mfma_f32_16x16x32_bf16 v[36:39], v[112:115], v[172:175], v[36:39]
    v_mfma_f32_16x16x32_bf16 v[40:43], v[104:107], v[176:179], v[40:43]
    v_mfma_f32_16x16x32_bf16 v[44:47], v[108:111], v[176:179], v[44:47]
    v_mfma_f32_16x16x32_bf16 v[48:51], v[112:115], v[176:179], v[48:51]
    s_nop 7
    v_cvt_pk_bf16_f32 v56, v16, v17
    v_cvt_pk_bf16_f32 v57, v18, v19
    buffer_store_dwordx2 v[56:57], v213, s[56:59], s72 offen offset:0
    v_cvt_pk_bf16_f32 v58, v20, v21
    v_cvt_pk_bf16_f32 v59, v22, v23
    buffer_store_dwordx2 v[58:59], v213, s[56:59], s72 offen offset:32
    v_cvt_pk_bf16_f32 v60, v24, v25
    v_cvt_pk_bf16_f32 v61, v26, v27
    buffer_store_dwordx2 v[60:61], v213, s[56:59], s72 offen offset:64
    v_cvt_pk_bf16_f32 v62, v28, v29
    v_cvt_pk_bf16_f32 v63, v30, v31
    buffer_store_dwordx2 v[62:63], v213, s[56:59], s73 offen offset:0
    v_cvt_pk_bf16_f32 v64, v32, v33
    v_cvt_pk_bf16_f32 v65, v34, v35
    buffer_store_dwordx2 v[64:65], v213, s[56:59], s73 offen offset:32
    v_cvt_pk_bf16_f32 v66, v36, v37
    v_cvt_pk_bf16_f32 v67, v38, v39
    buffer_store_dwordx2 v[66:67], v213, s[56:59], s73 offen offset:64
    v_cvt_pk_bf16_f32 v68, v40, v41
    v_cvt_pk_bf16_f32 v69, v42, v43
    buffer_store_dwordx2 v[68:69], v213, s[56:59], s74 offen offset:0
    v_cvt_pk_bf16_f32 v70, v44, v45
    v_cvt_pk_bf16_f32 v71, v46, v47
    buffer_store_dwordx2 v[70:71], v213, s[56:59], s74 offen offset:32
    v_cvt_pk_bf16_f32 v72, v48, v49
    v_cvt_pk_bf16_f32 v73, v50, v51
    buffer_store_dwordx2 v[72:73], v213, s[56:59], s74 offen offset:64
    s_branch C2D_39
C2E_38:
    ds_read_b64_tr_b16 v[56:57], v202 offset:0
    ds_read_b64_tr_b16 v[58:59], v202 offset:2560
    ds_read_b64_tr_b16 v[60:61], v202 offset:32
    ds_read_b64_tr_b16 v[62:63], v202 offset:2592
    ds_read_b64_tr_b16 v[68:69], v203 offset:0
    ds_read_b64_tr_b16 v[70:71], v203 offset:2560
    ds_read_b64_tr_b16 v[72:73], v203 offset:32
    ds_read_b64_tr_b16 v[74:75], v203 offset:2592
    ds_read_b64_tr_b16 v[80:81], v204 offset:0
    ds_read_b64_tr_b16 v[82:83], v204 offset:2560
    ds_read_b64_tr_b16 v[84:85], v204 offset:32
    ds_read_b64_tr_b16 v[86:87], v204 offset:2592
    ds_read_b64_tr_b16 v[92:93], v205 offset:0
    ds_read_b64_tr_b16 v[94:95], v205 offset:2560
    ds_read_b64_tr_b16 v[96:97], v205 offset:32
    ds_read_b64_tr_b16 v[98:99], v205 offset:2592
    ds_read_b64_tr_b16 v[104:105], v206 offset:0
    ds_read_b64_tr_b16 v[106:107], v206 offset:2560
    ds_read_b64_tr_b16 v[108:109], v206 offset:32
    ds_read_b64_tr_b16 v[110:111], v206 offset:2592
    s_waitcnt lgkmcnt(0)
    s_barrier
    ds_read_b128 v[120:123], v192 offset:0
    ds_read_b128 v[124:127], v192 offset:1280
    ds_read_b128 v[128:131], v192 offset:2560
    s_waitcnt lgkmcnt(0)
    v_mfma_f32_16x16x32_bf16 v[16:19], v[56:59], v[120:123], v[16:19]
    ds_read_b128 v[132:135], v193 offset:0
    ds_read_b128 v[136:139], v193 offset:1280
    ds_read_b128 v[140:143], v193 offset:2560
    ds_read_b128 v[144:147], v194 offset:0
    v_mfma_f32_16x16x32_bf16 v[20:23], v[60:63], v[120:123], v[20:23]
    ds_read_b128 v[148:151], v194 offset:1280
    ds_read_b128 v[152:155], v194 offset:2560
    ds_read_b128 v[156:159], v195 offset:0
    ds_read_b128 v[160:163], v195 offset:1280
    v_mfma_f32_16x16x32_bf16 v[28:31], v[56:59], v[124:127], v[28:31]
    ds_read_b128 v[164:167], v195 offset:2560
    ds_read_b128 v[168:171], v196 offset:0
    ds_read_b128 v[172:175], v196 offset:1280
    ds_read_b128 v[176:179], v196 offset:2560
    v_mfma_f32_16x16x32_bf16 v[32:35], v[60:63], v[124:127], v[32:35]
    v_add_u32 v197, 71680, v224
    v_add_u32 v207, 133120, v229
    v_add_u32 v198, 71680, v225
    v_add_u32 v208, 138240, v229
    v_mfma_f32_16x16x32_bf16 v[40:43], v[56:59], v[128:131], v[40:43]
    v_add_u32 v199, 71680, v226
    v_add_u32 v209, 143360, v229
    v_add_u32 v200, 71680, v227
    v_add_u32 v210, 148480, v229
    v_mfma_f32_16x16x32_bf16 v[44:47], v[60:63], v[128:131], v[44:47]
    v_add_u32 v201, 71680, v228
    v_add_u32 v211, 153600, v229
    s_waitcnt lgkmcnt(9)
    v_mfma_f32_16x16x32_bf16 v[16:19], v[68:71], v[132:135], v[16:19]
    ds_read_b64_tr_b16 v[56:57], v207 offset:0
    v_mfma_f32_16x16x32_bf16 v[20:23], v[72:75], v[132:135], v[20:23]
    ds_read_b64_tr_b16 v[58:59], v207 offset:2560
    v_mfma_f32_16x16x32_bf16 v[28:31], v[68:71], v[136:139], v[28:31]
    ds_read_b64_tr_b16 v[60:61], v207 offset:32
    v_mfma_f32_16x16x32_bf16 v[32:35], v[72:75], v[136:139], v[32:35]
    ds_read_b64_tr_b16 v[62:63], v207 offset:2592
    v_mfma_f32_16x16x32_bf16 v[40:43], v[68:71], v[140:143], v[40:43]
    v_mfma_f32_16x16x32_bf16 v[44:47], v[72:75], v[140:143], v[44:47]
    s_waitcnt lgkmcnt(10)
    v_mfma_f32_16x16x32_bf16 v[16:19], v[80:83], v[144:147], v[16:19]
    ds_read_b64_tr_b16 v[68:69], v208 offset:0
    v_mfma_f32_16x16x32_bf16 v[20:23], v[84:87], v[144:147], v[20:23]
    ds_read_b64_tr_b16 v[70:71], v208 offset:2560
    v_mfma_f32_16x16x32_bf16 v[28:31], v[80:83], v[148:151], v[28:31]
    ds_read_b64_tr_b16 v[72:73], v208 offset:32
    v_mfma_f32_16x16x32_bf16 v[32:35], v[84:87], v[148:151], v[32:35]
    ds_read_b64_tr_b16 v[74:75], v208 offset:2592
    v_mfma_f32_16x16x32_bf16 v[40:43], v[80:83], v[152:155], v[40:43]
    v_mfma_f32_16x16x32_bf16 v[44:47], v[84:87], v[152:155], v[44:47]
    s_waitcnt lgkmcnt(11)
    v_mfma_f32_16x16x32_bf16 v[16:19], v[92:95], v[156:159], v[16:19]
    ds_read_b64_tr_b16 v[80:81], v209 offset:0
    v_mfma_f32_16x16x32_bf16 v[20:23], v[96:99], v[156:159], v[20:23]
    ds_read_b64_tr_b16 v[82:83], v209 offset:2560
    v_mfma_f32_16x16x32_bf16 v[28:31], v[92:95], v[160:163], v[28:31]
    ds_read_b64_tr_b16 v[84:85], v209 offset:32
    v_mfma_f32_16x16x32_bf16 v[32:35], v[96:99], v[160:163], v[32:35]
    ds_read_b64_tr_b16 v[86:87], v209 offset:2592
    v_mfma_f32_16x16x32_bf16 v[40:43], v[92:95], v[164:167], v[40:43]
    v_mfma_f32_16x16x32_bf16 v[44:47], v[96:99], v[164:167], v[44:47]
    s_waitcnt lgkmcnt(12)
    s_barrier
    ds_read_b128 v[120:123], v197 offset:0
    ds_read_b128 v[124:127], v197 offset:1280
    ds_read_b128 v[128:131], v197 offset:2560
    v_mfma_f32_16x16x32_bf16 v[16:19], v[104:107], v[168:171], v[16:19]
    ds_read_b64_tr_b16 v[92:93], v210 offset:0
    v_mfma_f32_16x16x32_bf16 v[20:23], v[108:111], v[168:171], v[20:23]
    ds_read_b64_tr_b16 v[94:95], v210 offset:2560
    v_mfma_f32_16x16x32_bf16 v[28:31], v[104:107], v[172:175], v[28:31]
    ds_read_b64_tr_b16 v[96:97], v210 offset:32
    v_mfma_f32_16x16x32_bf16 v[32:35], v[108:111], v[172:175], v[32:35]
    ds_read_b64_tr_b16 v[98:99], v210 offset:2592
    v_mfma_f32_16x16x32_bf16 v[40:43], v[104:107], v[176:179], v[40:43]
    v_mfma_f32_16x16x32_bf16 v[44:47], v[108:111], v[176:179], v[44:47]
    s_waitcnt lgkmcnt(0)
    v_mfma_f32_16x16x32_bf16 v[16:19], v[56:59], v[120:123], v[16:19]
    ds_read_b64_tr_b16 v[104:105], v211 offset:0
    ds_read_b64_tr_b16 v[106:107], v211 offset:2560
    ds_read_b64_tr_b16 v[108:109], v211 offset:32
    ds_read_b64_tr_b16 v[110:111], v211 offset:2592
    ds_read_b128 v[132:135], v198 offset:0
    v_mfma_f32_16x16x32_bf16 v[20:23], v[60:63], v[120:123], v[20:23]
    ds_read_b128 v[136:139], v198 offset:1280
    ds_read_b128 v[140:143], v198 offset:2560
    ds_read_b128 v[144:147], v199 offset:0
    ds_read_b128 v[148:151], v199 offset:1280
    ds_read_b128 v[152:155], v199 offset:2560
    v_mfma_f32_16x16x32_bf16 v[28:31], v[56:59], v[124:127], v[28:31]
    ds_read_b128 v[156:159], v200 offset:0
    ds_read_b128 v[160:163], v200 offset:1280
    ds_read_b128 v[164:167], v200 offset:2560
    ds_read_b128 v[168:171], v201 offset:0
    ds_read_b128 v[172:175], v201 offset:1280
    v_mfma_f32_16x16x32_bf16 v[32:35], v[60:63], v[124:127], v[32:35]
    ds_read_b128 v[176:179], v201 offset:2560
    v_add_u32 v192, 102400, v224
    v_add_u32 v202, 158720, v229
    v_add_u32 v193, 102400, v225
    v_add_u32 v203, 0, v229
    v_mfma_f32_16x16x32_bf16 v[40:43], v[56:59], v[128:131], v[40:43]
    v_add_u32 v194, 102400, v226
    v_add_u32 v204, 5120, v229
    v_add_u32 v195, 102400, v227
    v_add_u32 v205, 10240, v229
    v_add_u32 v196, 102400, v228
    v_mfma_f32_16x16x32_bf16 v[44:47], v[60:63], v[128:131], v[44:47]
    v_add_u32 v206, 15360, v229
    s_waitcnt lgkmcnt(9)
    v_mfma_f32_16x16x32_bf16 v[16:19], v[68:71], v[132:135], v[16:19]
    ds_read_b64_tr_b16 v[56:57], v202 offset:0
    v_mfma_f32_16x16x32_bf16 v[20:23], v[72:75], v[132:135], v[20:23]
    ds_read_b64_tr_b16 v[58:59], v202 offset:2560
    v_mfma_f32_16x16x32_bf16 v[28:31], v[68:71], v[136:139], v[28:31]
    ds_read_b64_tr_b16 v[60:61], v202 offset:32
    v_mfma_f32_16x16x32_bf16 v[32:35], v[72:75], v[136:139], v[32:35]
    ds_read_b64_tr_b16 v[62:63], v202 offset:2592
    v_mfma_f32_16x16x32_bf16 v[40:43], v[68:71], v[140:143], v[40:43]
    v_mfma_f32_16x16x32_bf16 v[44:47], v[72:75], v[140:143], v[44:47]
    s_waitcnt lgkmcnt(10)
    v_mfma_f32_16x16x32_bf16 v[16:19], v[80:83], v[144:147], v[16:19]
    ds_read_b64_tr_b16 v[68:69], v203 offset:0
    v_mfma_f32_16x16x32_bf16 v[20:23], v[84:87], v[144:147], v[20:23]
    ds_read_b64_tr_b16 v[70:71], v203 offset:2560
    v_mfma_f32_16x16x32_bf16 v[28:31], v[80:83], v[148:151], v[28:31]
    ds_read_b64_tr_b16 v[72:73], v203 offset:32
    v_mfma_f32_16x16x32_bf16 v[32:35], v[84:87], v[148:151], v[32:35]
    ds_read_b64_tr_b16 v[74:75], v203 offset:2592
    v_mfma_f32_16x16x32_bf16 v[40:43], v[80:83], v[152:155], v[40:43]
    v_mfma_f32_16x16x32_bf16 v[44:47], v[84:87], v[152:155], v[44:47]
    s_waitcnt lgkmcnt(11)
    v_mfma_f32_16x16x32_bf16 v[16:19], v[92:95], v[156:159], v[16:19]
    ds_read_b64_tr_b16 v[80:81], v204 offset:0
    v_mfma_f32_16x16x32_bf16 v[20:23], v[96:99], v[156:159], v[20:23]
    ds_read_b64_tr_b16 v[82:83], v204 offset:2560
    v_mfma_f32_16x16x32_bf16 v[28:31], v[92:95], v[160:163], v[28:31]
    ds_read_b64_tr_b16 v[84:85], v204 offset:32
    v_mfma_f32_16x16x32_bf16 v[32:35], v[96:99], v[160:163], v[32:35]
    ds_read_b64_tr_b16 v[86:87], v204 offset:2592
    v_mfma_f32_16x16x32_bf16 v[40:43], v[92:95], v[164:167], v[40:43]
    v_mfma_f32_16x16x32_bf16 v[44:47], v[96:99], v[164:167], v[44:47]
    s_waitcnt lgkmcnt(12)
    s_barrier
    ds_read_b128 v[120:123], v192 offset:0
    ds_read_b128 v[124:127], v192 offset:1280
    ds_read_b128 v[128:131], v192 offset:2560
    v_mfma_f32_16x16x32_bf16 v[16:19], v[104:107], v[168:171], v[16:19]
    ds_read_b64_tr_b16 v[92:93], v205 offset:0
    v_mfma_f32_16x16x32_bf16 v[20:23], v[108:111], v[168:171], v[20:23]
    ds_read_b64_tr_b16 v[94:95], v205 offset:2560
    v_mfma_f32_16x16x32_bf16 v[28:31], v[104:107], v[172:175], v[28:31]
    ds_read_b64_tr_b16 v[96:97], v205 offset:32
    v_mfma_f32_16x16x32_bf16 v[32:35], v[108:111], v[172:175], v[32:35]
    ds_read_b64_tr_b16 v[98:99], v205 offset:2592
    v_mfma_f32_16x16x32_bf16 v[40:43], v[104:107], v[176:179], v[40:43]
    v_mfma_f32_16x16x32_bf16 v[44:47], v[108:111], v[176:179], v[44:47]
    s_waitcnt lgkmcnt(0)
    v_mfma_f32_16x16x32_bf16 v[16:19], v[56:59], v[120:123], v[16:19]
    ds_read_b64_tr_b16 v[104:105], v206 offset:0
    ds_read_b64_tr_b16 v[106:107], v206 offset:2560
    ds_read_b64_tr_b16 v[108:109], v206 offset:32
    ds_read_b64_tr_b16 v[110:111], v206 offset:2592
    ds_read_b128 v[132:135], v193 offset:0
    v_mfma_f32_16x16x32_bf16 v[20:23], v[60:63], v[120:123], v[20:23]
    ds_read_b128 v[136:139], v193 offset:1280
    ds_read_b128 v[140:143], v193 offset:2560
    ds_read_b128 v[144:147], v194 offset:0
    ds_read_b128 v[148:151], v194 offset:1280
    ds_read_b128 v[152:155], v194 offset:2560
    v_mfma_f32_16x16x32_bf16 v[28:31], v[56:59], v[124:127], v[28:31]
    ds_read_b128 v[156:159], v195 offset:0
    ds_read_b128 v[160:163], v195 offset:1280
    ds_read_b128 v[164:167], v195 offset:2560
    ds_read_b128 v[168:171], v196 offset:0
    ds_read_b128 v[172:175], v196 offset:1280
    v_mfma_f32_16x16x32_bf16 v[32:35], v[60:63], v[124:127], v[32:35]
    ds_read_b128 v[176:179], v196 offset:2560
    v_add_u32 v197, 40960, v224
    v_add_u32 v207, 20480, v229
    v_add_u32 v198, 40960, v225
    v_add_u32 v208, 25600, v229
    v_mfma_f32_16x16x32_bf16 v[40:43], v[56:59], v[128:131], v[40:43]
    v_add_u32 v199, 40960, v226
    v_add_u32 v209, 30720, v229
    v_add_u32 v200, 40960, v227
    v_add_u32 v210, 35840, v229
    v_add_u32 v201, 40960, v228
    v_mfma_f32_16x16x32_bf16 v[44:47], v[60:63], v[128:131], v[44:47]
    v_add_u32 v211, 133120, v229
    s_waitcnt lgkmcnt(9)
    v_mfma_f32_16x16x32_bf16 v[16:19], v[68:71], v[132:135], v[16:19]
    ds_read_b64_tr_b16 v[56:57], v207 offset:0
    v_mfma_f32_16x16x32_bf16 v[20:23], v[72:75], v[132:135], v[20:23]
    ds_read_b64_tr_b16 v[58:59], v207 offset:2560
    v_mfma_f32_16x16x32_bf16 v[28:31], v[68:71], v[136:139], v[28:31]
    ds_read_b64_tr_b16 v[60:61], v207 offset:32
    v_mfma_f32_16x16x32_bf16 v[32:35], v[72:75], v[136:139], v[32:35]
    ds_read_b64_tr_b16 v[62:63], v207 offset:2592
    v_mfma_f32_16x16x32_bf16 v[40:43], v[68:71], v[140:143], v[40:43]
    v_mfma_f32_16x16x32_bf16 v[44:47], v[72:75], v[140:143], v[44:47]
    s_waitcnt lgkmcnt(10)
    v_mfma_f32_16x16x32_bf16 v[16:19], v[80:83], v[144:147], v[16:19]
    ds_read_b64_tr_b16 v[68:69], v208 offset:0
    v_mfma_f32_16x16x32_bf16 v[20:23], v[84:87], v[144:147], v[20:23]
    ds_read_b64_tr_b16 v[70:71], v208 offset:2560
    v_mfma_f32_16x16x32_bf16 v[28:31], v[80:83], v[148:151], v[28:31]
    ds_read_b64_tr_b16 v[72:73], v208 offset:32
    v_mfma_f32_16x16x32_bf16 v[32:35], v[84:87], v[148:151], v[32:35]
    ds_read_b64_tr_b16 v[74:75], v208 offset:2592
    v_mfma_f32_16x16x32_bf16 v[40:43], v[80:83], v[152:155], v[40:43]
    v_mfma_f32_16x16x32_bf16 v[44:47], v[84:87], v[152:155], v[44:47]
    s_waitcnt lgkmcnt(11)
    v_mfma_f32_16x16x32_bf16 v[16:19], v[92:95], v[156:159], v[16:19]
    ds_read_b64_tr_b16 v[80:81], v209 offset:0
    v_mfma_f32_16x16x32_bf16 v[20:23], v[96:99], v[156:159], v[20:23]
    ds_read_b64_tr_b16 v[82:83], v209 offset:2560
    v_mfma_f32_16x16x32_bf16 v[28:31], v[92:95], v[160:163], v[28:31]
    ds_read_b64_tr_b16 v[84:85], v209 offset:32
    v_mfma_f32_16x16x32_bf16 v[32:35], v[96:99], v[160:163], v[32:35]
    ds_read_b64_tr_b16 v[86:87], v209 offset:2592
    v_mfma_f32_16x16x32_bf16 v[40:43], v[92:95], v[164:167], v[40:43]
    v_mfma_f32_16x16x32_bf16 v[44:47], v[96:99], v[164:167], v[44:47]
    s_waitcnt lgkmcnt(12)
    s_barrier
    ds_read_b128 v[120:123], v197 offset:0
    ds_read_b128 v[124:127], v197 offset:1280
    ds_read_b128 v[128:131], v197 offset:2560
    v_mfma_f32_16x16x32_bf16 v[16:19], v[104:107], v[168:171], v[16:19]
    ds_read_b64_tr_b16 v[92:93], v210 offset:0
    v_mfma_f32_16x16x32_bf16 v[20:23], v[108:111], v[168:171], v[20:23]
    ds_read_b64_tr_b16 v[94:95], v210 offset:2560
    v_mfma_f32_16x16x32_bf16 v[28:31], v[104:107], v[172:175], v[28:31]
    ds_read_b64_tr_b16 v[96:97], v210 offset:32
    v_mfma_f32_16x16x32_bf16 v[32:35], v[108:111], v[172:175], v[32:35]
    ds_read_b64_tr_b16 v[98:99], v210 offset:2592
    v_mfma_f32_16x16x32_bf16 v[40:43], v[104:107], v[176:179], v[40:43]
    v_mfma_f32_16x16x32_bf16 v[44:47], v[108:111], v[176:179], v[44:47]
    s_waitcnt lgkmcnt(0)
    v_mfma_f32_16x16x32_bf16 v[16:19], v[56:59], v[120:123], v[16:19]
    ds_read_b64_tr_b16 v[104:105], v211 offset:0
    ds_read_b64_tr_b16 v[106:107], v211 offset:2560
    ds_read_b64_tr_b16 v[108:109], v211 offset:32
    v_mfma_f32_16x16x32_bf16 v[20:23], v[60:63], v[120:123], v[20:23]
    ds_read_b64_tr_b16 v[110:111], v211 offset:2592
    ds_read_b128 v[132:135], v198 offset:0
    ds_read_b128 v[136:139], v198 offset:1280
    v_mfma_f32_16x16x32_bf16 v[28:31], v[56:59], v[124:127], v[28:31]
    ds_read_b128 v[140:143], v198 offset:2560
    ds_read_b128 v[144:147], v199 offset:0
    ds_read_b128 v[148:151], v199 offset:1280
    v_mfma_f32_16x16x32_bf16 v[32:35], v[60:63], v[124:127], v[32:35]
    ds_read_b128 v[152:155], v199 offset:2560
    ds_read_b128 v[156:159], v200 offset:0
    ds_read_b128 v[160:163], v200 offset:1280
    v_mfma_f32_16x16x32_bf16 v[40:43], v[56:59], v[128:131], v[40:43]
    ds_read_b128 v[164:167], v200 offset:2560
    ds_read_b128 v[168:171], v201 offset:0
    ds_read_b128 v[172:175], v201 offset:1280
    v_mfma_f32_16x16x32_bf16 v[44:47], v[60:63], v[128:131], v[44:47]
    ds_read_b128 v[176:179], v201 offset:2560
    s_waitcnt lgkmcnt(9)
    v_mfma_f32_16x16x32_bf16 v[16:19], v[68:71], v[132:135], v[16:19]
    v_mfma_f32_16x16x32_bf16 v[20:23], v[72:75], v[132:135], v[20:23]
    v_mfma_f32_16x16x32_bf16 v[28:31], v[68:71], v[136:139], v[28:31]
    v_mfma_f32_16x16x32_bf16 v[32:35], v[72:75], v[136:139], v[32:35]
    v_mfma_f32_16x16x32_bf16 v[40:43], v[68:71], v[140:143], v[40:43]
    v_mfma_f32_16x16x32_bf16 v[44:47], v[72:75], v[140:143], v[44:47]
    s_waitcnt lgkmcnt(6)
    v_mfma_f32_16x16x32_bf16 v[16:19], v[80:83], v[144:147], v[16:19]
    v_mfma_f32_16x16x32_bf16 v[20:23], v[84:87], v[144:147], v[20:23]
    v_mfma_f32_16x16x32_bf16 v[28:31], v[80:83], v[148:151], v[28:31]
    v_mfma_f32_16x16x32_bf16 v[32:35], v[84:87], v[148:151], v[32:35]
    v_mfma_f32_16x16x32_bf16 v[40:43], v[80:83], v[152:155], v[40:43]
    v_mfma_f32_16x16x32_bf16 v[44:47], v[84:87], v[152:155], v[44:47]
    s_waitcnt lgkmcnt(3)
    v_mfma_f32_16x16x32_bf16 v[16:19], v[92:95], v[156:159], v[16:19]
    v_mfma_f32_16x16x32_bf16 v[20:23], v[96:99], v[156:159], v[20:23]
    v_mfma_f32_16x16x32_bf16 v[28:31], v[92:95], v[160:163], v[28:31]
    v_mfma_f32_16x16x32_bf16 v[32:35], v[96:99], v[160:163], v[32:35]
    v_mfma_f32_16x16x32_bf16 v[40:43], v[92:95], v[164:167], v[40:43]
    v_mfma_f32_16x16x32_bf16 v[44:47], v[96:99], v[164:167], v[44:47]
    s_waitcnt lgkmcnt(0)
    v_mfma_f32_16x16x32_bf16 v[16:19], v[104:107], v[168:171], v[16:19]
    v_mfma_f32_16x16x32_bf16 v[20:23], v[108:111], v[168:171], v[20:23]
    v_mfma_f32_16x16x32_bf16 v[28:31], v[104:107], v[172:175], v[28:31]
    v_mfma_f32_16x16x32_bf16 v[32:35], v[108:111], v[172:175], v[32:35]
    v_mfma_f32_16x16x32_bf16 v[40:43], v[104:107], v[176:179], v[40:43]
    v_mfma_f32_16x16x32_bf16 v[44:47], v[108:111], v[176:179], v[44:47]
    s_nop 7
    v_cvt_pk_bf16_f32 v56, v16, v17
    v_cvt_pk_bf16_f32 v57, v18, v19
    buffer_store_dwordx2 v[56:57], v213, s[56:59], s72 offen offset:0
    v_cvt_pk_bf16_f32 v58, v20, v21
    v_cvt_pk_bf16_f32 v59, v22, v23
    buffer_store_dwordx2 v[58:59], v213, s[56:59], s72 offen offset:32
    v_cvt_pk_bf16_f32 v62, v28, v29
    v_cvt_pk_bf16_f32 v63, v30, v31
    buffer_store_dwordx2 v[62:63], v213, s[56:59], s73 offen offset:0
    v_cvt_pk_bf16_f32 v64, v32, v33
    v_cvt_pk_bf16_f32 v65, v34, v35
    buffer_store_dwordx2 v[64:65], v213, s[56:59], s73 offen offset:32
    v_cvt_pk_bf16_f32 v68, v40, v41
    v_cvt_pk_bf16_f32 v69, v42, v43
    buffer_store_dwordx2 v[68:69], v213, s[56:59], s74 offen offset:0
    v_cvt_pk_bf16_f32 v70, v44, v45
    v_cvt_pk_bf16_f32 v71, v46, v47
    buffer_store_dwordx2 v[70:71], v213, s[56:59], s74 offen offset:32
C2D_39:
    s_branch BJ2_33
BLD_32:
    ds_read_b128 v[16:19], v216 offset:0
    ds_read_b128 v[20:23], v216 offset:4096
    ds_read_b128 v[24:27], v216 offset:8192
    ds_read_b128 v[28:31], v216 offset:12288
    s_waitcnt lgkmcnt(0)
    buffer_store_dwordx4 v[16:19], v217, s[48:51], 0 offen sc1
    buffer_store_dwordx4 v[20:23], v218, s[48:51], 0 offen sc1
    buffer_store_dwordx4 v[24:27], v219, s[48:51], 0 offen sc1
    buffer_store_dwordx4 v[28:31], v220, s[48:51], 0 offen sc1
    s_barrier
    s_waitcnt vmcnt(0)
    s_barrier
    s_add_u32 s47, s62, 11
WO_40:
    s_cmp_ge_u32 s47, 19
    s_cbranch_scc1 WO_41
    s_mul_i32 s6, s47, 52
    s_lshr_b32 s6, s6, 8
    s_mul_i32 s7, s6, 5
    s_sub_u32 s7, s47, s7
    s_add_u32 s6, s6, s68
    s_and_b32 s6, s6, 3
    s_mul_i32 s6, s6, 5
    s_add_u32 s7, s7, s6
    s_mul_i32 s7, s7, 40960
    s_mul_i32 s6, s47, 5120
    s_add_u32 s6, s6, 0xffff2400
    s_add_u32 m0, s6, 0
    s_nop 0
    buffer_load_dwordx4 v230, s[56:59], s7 offen lds
    s_add_u32 m0, s6, 1024
    s_nop 0
    buffer_load_dwordx4 v231, s[56:59], s7 offen lds
    s_add_u32 m0, s6, 2048
    s_nop 0
    buffer_load_dwordx4 v232, s[56:59], s7 offen lds
    s_add_u32 m0, s6, 3072
    s_nop 0
    buffer_load_dwordx4 v233, s[56:59], s7 offen lds
    s_add_u32 m0, s6, 4096
    s_nop 0
    buffer_load_dwordx4 v234, s[56:59], s7 offen lds
    s_add_u32 s47, s47, 4
    s_branch WO_40
WO_41:
    s_mov_b32 s52, s30
    s_mov_b32 s53, s31
    s_mov_b32 s54, 0x280000
    s_mov_b32 s55, 0x00020000
    v_lshlrev_b32 v239, 4, v1
    s_add_u32 s47, s62, 0
    s_lshl_b32 s6, s47, 10
    v_add_u32 v10, s6, v239
    v_lshrrev_b32 v11, 9, v10
    v_mul_u32_u24 v11, 4370, v11
    v_lshrrev_b32 v11, 16, v11
    v_mul_u32_u24 v11, 156160, v11
    v_add_u32 v200, v10, v11
    s_add_u32 s47, s62, 4
    s_lshl_b32 s6, s47, 10
    v_add_u32 v10, s6, v239
    v_lshrrev_b32 v11, 9, v10
    v_mul_u32_u24 v11, 4370, v11
    v_lshrrev_b32 v11, 16, v11
    v_mul_u32_u24 v11, 156160, v11
    v_add_u32 v201, v10, v11
    s_add_u32 s47, s62, 8
    s_lshl_b32 s6, s47, 10
    v_add_u32 v10, s6, v239
    v_lshrrev_b32 v11, 9, v10
    v_mul_u32_u24 v11, 4370, v11
    v_lshrrev_b32 v11, 16, v11
    v_mul_u32_u24 v11, 156160, v11
    v_add_u32 v202, v10, v11
    s_add_u32 s47, s62, 12
    s_lshl_b32 s6, s47, 10
    v_add_u32 v10, s6, v239
    v_lshrrev_b32 v11, 9, v10
    v_mul_u32_u24 v11, 4370, v11
    v_lshrrev_b32 v11, 16, v11
    v_mul_u32_u24 v11, 156160, v11
    v_add_u32 v203, v10, v11
    s_add_u32 s47, s62, 16
    s_lshl_b32 s6, s47, 10
    v_add_u32 v10, s6, v239
    v_lshrrev_b32 v11, 9, v10
    v_mul_u32_u24 v11, 4370, v11
    v_lshrrev_b32 v11, 16, v11
    v_mul_u32_u24 v11, 156160, v11
    v_add_u32 v204, v10, v11
    s_add_u32 s47, s62, 20
    s_lshl_b32 s6, s47, 10
    v_add_u32 v10, s6, v239
    v_lshrrev_b32 v11, 9, v10
    v_mul_u32_u24 v11, 4370, v11
    v_lshrrev_b32 v11, 16, v11
    v_mul_u32_u24 v11, 156160, v11
    v_add_u32 v205, v10, v11
    s_add_u32 s47, s62, 24
    s_lshl_b32 s6, s47, 10
    v_add_u32 v10, s6, v239
    v_lshrrev_b32 v11, 9, v10
    v_mul_u32_u24 v11, 4370, v11
    v_lshrrev_b32 v11, 16, v11
    v_mul_u32_u24 v11, 156160, v11
    v_add_u32 v206, v10, v11
    s_add_u32 s47, s62, 28
    s_lshl_b32 s6, s47, 10
    v_add_u32 v10, s6, v239
    v_lshrrev_b32 v11, 9, v10
    v_mul_u32_u24 v11, 4370, v11
    v_lshrrev_b32 v11, 16, v11
    v_mul_u32_u24 v11, 156160, v11
    v_add_u32 v207, v10, v11
    s_cmp_lt_u32 s62, 2
    s_cselect_b64 vcc, -1, 0
    v_mov_b32 v10, 0x80000000
    v_cndmask_b32 v207, v10, v207, vcc
    s_mul_i32 s49, s67, 7680
    s_waitcnt vmcnt(0)
    s_barrier
    s_add_u32 s50, s68, 0
    s_and_b32 s50, s50, 3
    s_mul_i32 s50, s50, 655360
    s_add_u32 s50, s50, s49
    s_lshl_b32 s6, s62, 10
    s_add_u32 s6, s6, 40960
    s_add_u32 m0, s6, 0
    s_nop 0
    buffer_load_dwordx4 v200, s[52:55], s50 offen sc1 lds
    s_add_u32 m0, s6, 4096
    s_nop 0
    buffer_load_dwordx4 v201, s[52:55], s50 offen sc1 lds
    s_add_u32 m0, s6, 8192
    s_nop 0
    buffer_load_dwordx4 v202, s[52:55], s50 offen sc1 lds
    s_add_u32 m0, s6, 12288
    s_nop 0
    buffer_load_dwordx4 v203, s[52:55], s50 offen sc1 lds
    s_add_u32 m0, s6, 16384
    s_nop 0
    buffer_load_dwordx4 v204, s[52:55], s50 offen sc1 lds
    s_add_u32 m0, s6, 20480
    s_nop 0
    buffer_load_dwordx4 v205, s[52:55], s50 offen sc1 lds
    s_add_u32 m0, s6, 24576
    s_nop 0
    buffer_load_dwordx4 v206, s[52:55], s50 offen sc1 lds
    s_cmp_ge_u32 s62, 2
    s_cbranch_scc1 O7_42
    s_add_u32 m0, s6, 28672
    s_nop 0
    buffer_load_dwordx4 v207, s[52:55], s50 offen sc1 lds
O7_42:
    s_add_u32 s50, s68, 1
    s_and_b32 s50, s50, 3
    s_mul_i32 s50, s50, 655360
    s_add_u32 s50, s50, s49
    s_lshl_b32 s6, s62, 10
    s_add_u32 s6, s6, 71680
    s_add_u32 m0, s6, 0
    s_nop 0
    buffer_load_dwordx4 v200, s[52:55], s50 offen sc1 lds
    s_add_u32 m0, s6, 4096
    s_nop 0
    buffer_load_dwordx4 v201, s[52:55], s50 offen sc1 lds
    s_add_u32 m0, s6, 8192
    s_nop 0
    buffer_load_dwordx4 v202, s[52:55], s50 offen sc1 lds
    s_add_u32 m0, s6, 12288
    s_nop 0
    buffer_load_dwordx4 v203, s[52:55], s50 offen sc1 lds
    s_add_u32 m0, s6, 16384
    s_nop 0
    buffer_load_dwordx4 v204, s[52:55], s50 offen sc1 lds
    s_add_u32 m0, s6, 20480
    s_nop 0
    buffer_load_dwordx4 v205, s[52:55], s50 offen sc1 lds
    s_add_u32 m0, s6, 24576
    s_nop 0
    buffer_load_dwordx4 v206, s[52:55], s50 offen sc1 lds
    s_cmp_ge_u32 s62, 2
    s_cbranch_scc1 O7_43
    s_add_u32 m0, s6, 28672
    s_nop 0
    buffer_load_dwordx4 v207, s[52:55], s50 offen sc1 lds
O7_43:
    s_waitcnt vmcnt(7)
    s_barrier
    s_add_u32 s50, s68, 2
    s_and_b32 s50, s50, 3
    s_mul_i32 s50, s50, 655360
    s_add_u32 s50, s50, s49
    s_lshl_b32 s6, s62, 10
    s_add_u32 s6, s6, 102400
    s_add_u32 m0, s6, 0
    s_nop 0
    buffer_load_dwordx4 v200, s[52:55], s50 offen sc1 lds
    s_add_u32 m0, s6, 4096
    s_nop 0
    buffer_load_dwordx4 v201, s[52:55], s50 offen sc1 lds
    s_add_u32 m0, s6, 8192
    s_nop 0
    buffer_load_dwordx4 v202, s[52:55], s50 offen sc1 lds
    s_add_u32 m0, s6, 12288
    s_nop 0
    buffer_load_dwordx4 v203, s[52:55], s50 offen sc1 lds
    s_add_u32 m0, s6, 16384
    s_nop 0
    buffer_load_dwordx4 v204, s[52:55], s50 offen sc1 lds
    s_add_u32 m0, s6, 20480
    s_nop 0
    buffer_load_dwordx4 v205, s[52:55], s50 offen sc1 lds
    s_add_u32 m0, s6, 24576
    s_nop 0
    buffer_load_dwordx4 v206, s[52:55], s50 offen sc1 lds
    s_cmp_ge_u32 s62, 2
    s_cbranch_scc1 O7_44
    s_add_u32 m0, s6, 28672
    s_nop 0
    buffer_load_dwordx4 v207, s[52:55], s50 offen sc1 lds
O7_44:
    s_waitcnt vmcnt(7)
    s_barrier
    s_add_u32 s50, s68, 3
    s_and_b32 s50, s50, 3
    s_mul_i32 s50, s50, 655360
    s_add_u32 s50, s50, s49
    s_lshl_b32 s6, s62, 10
    s_add_u32 s6, s6, 40960
    s_add_u32 m0, s6, 0
    s_nop 0
    buffer_load_dwordx4 v200, s[52:55], s50 offen sc1 lds
    s_add_u32 m0, s6, 4096
    s_nop 0
    buffer_load_dwordx4 v201, s[52:55], s50 offen sc1 lds
    s_add_u32 m0, s6, 8192
    s_nop 0
    buffer_load_dwordx4 v202, s[52:55], s50 offen sc1 lds
    s_add_u32 m0, s6, 12288
    s_nop 0
    buffer_load_dwordx4 v203, s[52:55], s50 offen sc1 lds
    s_add_u32 m0, s6, 16384
    s_nop 0
    buffer_load_dwordx4 v204, s[52:55], s50 offen sc1 lds
    s_add_u32 m0, s6, 20480
    s_nop 0
    buffer_load_dwordx4 v205, s[52:55], s50 offen sc1 lds
    s_add_u32 m0, s6, 24576
    s_nop 0
    buffer_load_dwordx4 v206, s[52:55], s50 offen sc1 lds
    s_cmp_ge_u32 s62, 2
    s_cbranch_scc1 O7_45
    s_add_u32 m0, s6, 28672
    s_nop 0
    buffer_load_dwordx4 v207, s[52:55], s50 offen sc1 lds
O7_45:
    s_waitcnt vmcnt(7)
    s_barrier
    s_cmp_lg_u32 s62, 0
    s_cbranch_scc1 W19_46
    s_add_u32 s7, s68, 3
    s_and_b32 s7, s7, 3
    s_mul_i32 s7, s7, 5
    s_add_u32 s7, s7, 4
    s_mul_i32 s7, s7, 40960
    s_mov_b32 m0, 133120
    s_nop 0
    buffer_load_dwordx4 v230, s[56:59], s7 offen lds
    s_mov_b32 m0, 134144
    s_nop 0
    buffer_load_dwordx4 v231, s[56:59], s7 offen lds
    s_mov_b32 m0, 135168
    s_nop 0
    buffer_load_dwordx4 v232, s[56:59], s7 offen lds
    s_mov_b32 m0, 136192
    s_nop 0
    buffer_load_dwordx4 v233, s[56:59], s7 offen lds
    s_mov_b32 m0, 137216
    s_nop 0
    buffer_load_dwordx4 v234, s[56:59], s7 offen lds
W19_46:
    s_waitcnt vmcnt(0)
    s_barrier
BJ2_33:
    s_branch K_FIN
A_ROLE:
    s_sub_u32 s5, s5, s70
    s_lshl_b32 s6, s4, 1
    s_add_u32 s7, s4, 2
    s_cmp_lt_u32 s4, 2
    s_cselect_b32 s6, s6, s7
    s_lshr_b32 s7, s5, 3
    s_add_u32 s73, s6, s7
    s_and_b32 s72, s5, 7
    s_lshl_b32 s62, s73, 6
    s_lshl_b32 s6, s72, 3
    s_add_u32 s62, s62, s6
    s_add_u32 s63, s62, s3
    s_mov_b32 s32, s10
    s_mov_b32 s33, s11
    s_mov_b32 s34, 0x280000
    s_mov_b32 s35, 0x00020000
    s_mov_b32 s36, s12
    s_mov_b32 s37, s13
    s_mov_b32 s38, 0x280000
    s_mov_b32 s39, 0x00020000
    s_mov_b32 s40, s14
    s_mov_b32 s41, s15
    s_mov_b32 s42, 0x1400
    s_mov_b32 s43, 0x00020000
    v_and_b32 v8, 7, v1
    v_lshrrev_b32 v9, 3, v1
    s_lshl_b32 s6, s3, 3
    v_add_u32 v9, s6, v9
    v_lshlrev_b32 v2, 2, v9
    s_lshl_b32 s6, s72, 8
    v_add_u32 v2, s6, v2
    v_mul_u32_u24 v2, 1280, v2
    v_lshlrev_b32 v3, 4, v8
    s_lshl_b32 s6, s73, 7
    v_add3_u32 v2, v2, v3, s6
    v_add_u32 v3, -3840, v2
    v_add_u32 v4, -2560, v2
    v_add_u32 v5, -1280, v2
    buffer_load_dwordx4 v[64:67], v2, s[32:35], 0 offen
    buffer_load_dwordx4 v[68:71], v2, s[32:35], 0 offen offset:1280
    buffer_load_dwordx4 v[72:75], v2, s[32:35], 0 offen offset:2560
    buffer_load_dwordx4 v[76:79], v2, s[32:35], 0 offen offset:3840
    buffer_load_dwordx4 v[80:83], v2, s[36:39], 0 offen
    buffer_load_dwordx4 v[84:87], v2, s[36:39], 0 offen offset:1280
    buffer_load_dwordx4 v[88:91], v2, s[36:39], 0 offen offset:2560
    buffer_load_dwordx4 v[92:95], v2, s[36:39], 0 offen offset:3840
    buffer_load_dwordx4 v[52:55], v3, s[32:35], 0 offen
    buffer_load_dwordx4 v[56:59], v4, s[32:35], 0 offen
    buffer_load_dwordx4 v[60:63], v5, s[32:35], 0 offen
    v_lshlrev_b32 v6, 6, v8
    s_lshl_b32 s6, s73, 9
    v_add_u32 v6, s6, v6
    buffer_load_dwordx4 v[32:35], v6, s[40:43], 0 offen
    buffer_load_dwordx4 v[36:39], v6, s[40:43], 0 offen offset:16
    buffer_load_dwordx4 v[40:43], v6, s[40:43], 0 offen offset:32
    buffer_load_dwordx4 v[44:47], v6, s[40:43], 0 offen offset:48
    s_lshl_b32 s6, s73, 7
    s_add_u32 s6, s6, 53248
    s_add_u32 s48, s30, 0x780000
    s_addc_u32 s49, s31, 0
    s_mov_b32 s50, 0x10000
    s_mov_b32 s51, 0x00020000
    v_mov_b32 v251, s6
    buffer_load_dword v250, v251, s[48:51], 0 offen sc1
    s_lshl_b32 s6, s62, 1
    s_add_u32 s44, s18, s6
    s_addc_u32 s45, s19, 0
    s_load_dwordx4 s[64:67], s[44:45], 0
    s_cmp_eq_u32 s4, 1
    s_cselect_b32 s74, 1, 0
    s_cmp_ge_u32 s4, 5
    s_cselect_b32 s74, 1, s74
    s_cselect_b32 s7, 3, 0
    s_sub_u32 s6, s4, 2
    s_sub_u32 s6, s6, s7
    s_mul_i32 s6, s6, 3
    s_add_u32 s6, s6, 2
    s_cmp_lt_u32 s4, 2
    s_cselect_b32 s75, 0, s6
    s_cselect_b32 s76, 128, 64
    s_cselect_b32 s77, 2400, s76
    s_movk_i32 s77, 3552
    s_cmp_lt_u32 s4, 2
    s_cselect_b32 s77, 2400, s77
    s_lshl_b32 s78, s5, 3
    s_add_u32 s78, s78, s3
    s_mov_b32 s52, s22
    s_mov_b32 s53, s23
    s_mov_b32 s54, 0x258000
    s_mov_b32 s55, 0x00020000
    s_mov_b32 s56, s20
    s_mov_b32 s57, s21
    s_mov_b32 s58, 0x280000
    s_mov_b32 s59, 0x00020000
    v_mov_b32 v20, 0x80000000
    s_movk_i32 s77, 3552
    s_cmp_lt_u32 s4, 2
    s_cselect_b32 s77, 2400, s77
    s_mul_i32 s6, s76, 0
    s_add_u32 s6, s6, s78
    s_lshl_b32 s6, s6, 6
    v_add_u32 v21, s6, v1
    v_mul_u32_u24 v22, 34953, v21
    v_lshrrev_b32 v22, 19, v22
    v_mul_u32_u24 v23, 15, v22
    v_sub_u32 v23, v21, v23
    v_mul_u32_u24 v24, 52, v23
    v_lshrrev_b32 v24, 8, v24
    v_mul_u32_u24 v25, 5, v24
    v_sub_u32 v25, v23, v25
    v_add_u32 v22, 192, v22
    v_mul_u32_u24 v22, 3840, v22
    v_mul_u32_u24 v24, 1280, v24
    v_lshlrev_b32 v25, 7, v25
    v_add3_u32 v22, v22, v24, v25
    s_mul_i32 s7, s74, 640
    v_add_u32 v22, s7, v22
    s_movk_i32 s7, 6720
    v_cmp_gt_u32 vcc, s7, v21
    s_nop 1
    v_cndmask_b32 v22, v20, v22, vcc
    buffer_load_dword v230, v22, s[52:55], 0 offen
    s_mul_i32 s6, s76, 0
    s_add_u32 s6, s6, s78
    s_lshl_b32 s6, s6, 6
    v_add_u32 v21, s6, v1
    v_mul_u32_u24 v22, 87382, v21
    v_lshrrev_b32 v22, 19, v22
    v_mul_u32_u24 v23, 6, v22
    v_sub_u32 v23, v21, v23
    s_mul_i32 s6, s75, 192
    s_sub_u32 s6, s6, 16
    v_add_u32 v22, s6, v22
    s_movk_i32 s7, 1280
    v_mul_lo_u32 v22, v22, s7
    v_lshlrev_b32 v23, 7, v23
    v_add_u32 v22, v22, v23
    v_add_u32 v22, 512, v22
    v_cmp_gt_u32 vcc, s77, v21
    s_nop 1
    v_cndmask_b32 v22, v20, v22, vcc
    buffer_load_dword v231, v22, s[56:59], 0 offen
    s_mul_i32 s6, s76, 1
    s_add_u32 s6, s6, s78
    s_lshl_b32 s6, s6, 6
    v_add_u32 v21, s6, v1
    v_mul_u32_u24 v22, 34953, v21
    v_lshrrev_b32 v22, 19, v22
    v_mul_u32_u24 v23, 15, v22
    v_sub_u32 v23, v21, v23
    v_mul_u32_u24 v24, 52, v23
    v_lshrrev_b32 v24, 8, v24
    v_mul_u32_u24 v25, 5, v24
    v_sub_u32 v25, v23, v25
    v_add_u32 v22, 192, v22
    v_mul_u32_u24 v22, 3840, v22
    v_mul_u32_u24 v24, 1280, v24
    v_lshlrev_b32 v25, 7, v25
    v_add3_u32 v22, v22, v24, v25
    s_mul_i32 s7, s74, 640
    v_add_u32 v22, s7, v22
    s_movk_i32 s7, 6720
    v_cmp_gt_u32 vcc, s7, v21
    s_nop 1
    v_cndmask_b32 v22, v20, v22, vcc
    buffer_load_dword v232, v22, s[52:55], 0 offen
    s_mul_i32 s60, s3, 17920
    s_lshl_b32 s59, s63, 12
    v_lshlrev_b32 v10, 4, v1
    v_add_u32 v11, -2, v10
    v_mov_b32 v28, 0
    v_mov_b32 v29, 0
    v_mov_b32 v30, 0
    v_mov_b32 v31, 0
    v_add_u32 v23, s60, v10
    s_mov_b64 exec, 0xfffffff
    ds_write_b128 v23, v[28:31] offset:0
    ds_write_b128 v23, v[28:31] offset:4640
    s_mov_b64 exec, -1
    v_mul_u32_u24 v7, 17936, v8
    v_lshlrev_b32 v12, 3, v9
    v_sub_u32 v7, v7, v12
    v_add_u32 v7, 9720, v7
    s_mov_b32 s57, 0xffff0000
    s_waitcnt vmcnt(4)
    v_lshlrev_b32 v96, 16, v32
    v_lshlrev_b32 v97, 16, v34
    v_and_b32 v98, s57, v32
    v_and_b32 v99, s57, v34
    v_lshlrev_b32 v100, 16, v33
    v_lshlrev_b32 v101, 16, v35
    v_and_b32 v102, s57, v33
    v_and_b32 v103, s57, v35
    v_lshlrev_b32 v104, 16, v36
    v_lshlrev_b32 v105, 16, v38
    v_and_b32 v106, s57, v36
    v_and_b32 v107, s57, v38
    v_lshlrev_b32 v108, 16, v37
    v_lshlrev_b32 v109, 16, v39
    v_and_b32 v110, s57, v37
    v_and_b32 v111, s57, v39
    v_lshlrev_b32 v112, 16, v40
    v_lshlrev_b32 v113, 16, v42
    v_and_b32 v114, s57, v40
    v_and_b32 v115, s57, v42
    v_lshlrev_b32 v116, 16, v41
    v_lshlrev_b32 v117, 16, v43
    v_and_b32 v118, s57, v41
    v_and_b32 v119, s57, v43
    v_lshlrev_b32 v120, 16, v44
    v_lshlrev_b32 v121, 16, v46
    v_and_b32 v122, s57, v44
    v_and_b32 v123, s57, v46
    v_lshlrev_b32 v124, 16, v45
    v_lshlrev_b32 v125, 16, v47
    v_and_b32 v126, s57, v45
    v_and_b32 v127, s57, v47
    v_lshlrev_b32 v128, 16, v52
    v_and_b32 v129, s57, v52
    v_lshlrev_b32 v130, 16, v56
    v_and_b32 v131, s57, v56
    v_lshlrev_b32 v132, 16, v60
    v_and_b32 v133, s57, v60
    v_lshlrev_b32 v134, 16, v64
    v_and_b32 v135, s57, v64
    v_lshlrev_b32 v136, 16, v68
    v_and_b32 v137, s57, v68
    v_lshlrev_b32 v138, 16, v72
    v_and_b32 v139, s57, v72
    v_lshlrev_b32 v140, 16, v76
    v_and_b32 v141, s57, v76
    v_lshlrev_b32 v142, 16, v80
    v_and_b32 v143, s57, v80
    v_lshlrev_b32 v144, 16, v84
    v_and_b32 v145, s57, v84
    v_lshlrev_b32 v146, 16, v88
    v_and_b32 v147, s57, v88
    v_lshlrev_b32 v148, 16, v92
    v_and_b32 v149, s57, v92
    v_pk_mul_f32 v[150:151], v[102:103], v[128:129]
    v_pk_mul_f32 v[152:153], v[102:103], v[130:131]
    v_pk_mul_f32 v[154:155], v[102:103], v[132:133]
    v_pk_mul_f32 v[156:157], v[102:103], v[134:135]
    v_pk_fma_f32 v[150:151], v[100:101], v[130:131], v[150:151]
    v_pk_fma_f32 v[152:153], v[100:101], v[132:133], v[152:153]
    v_pk_fma_f32 v[154:155], v[100:101], v[134:135], v[154:155]
    v_pk_fma_f32 v[156:157], v[100:101], v[136:137], v[156:157]
    v_pk_fma_f32 v[150:151], v[98:99], v[132:133], v[150:151]
    v_pk_fma_f32 v[152:153], v[98:99], v[134:135], v[152:153]
    v_pk_fma_f32 v[154:155], v[98:99], v[136:137], v[154:155]
    v_pk_fma_f32 v[156:157], v[98:99], v[138:139], v[156:157]
    v_pk_fma_f32 v[150:151], v[96:97], v[134:135], v[150:151]
    v_pk_fma_f32 v[152:153], v[96:97], v[136:137], v[152:153]
    v_pk_fma_f32 v[154:155], v[96:97], v[138:139], v[154:155]
    v_pk_fma_f32 v[156:157], v[96:97], v[140:141], v[156:157]
    v_pk_mul_f32 v[150:151], v[150:151], v[142:143]
    v_pk_mul_f32 v[152:153], v[152:153], v[144:145]
    v_pk_mul_f32 v[154:155], v[154:155], v[146:147]
    v_pk_mul_f32 v[156:157], v[156:157], v[148:149]
    v_cvt_pk_bf16_f32 v160, v156, v154
    v_cvt_pk_bf16_f32 v161, v152, v150
    ds_write_b64 v7, v[160:161] offset:0
    v_cvt_pk_bf16_f32 v162, v157, v155
    v_cvt_pk_bf16_f32 v163, v153, v151
    ds_write_b64 v7, v[162:163] offset:528
    v_lshlrev_b32 v128, 16, v53
    v_and_b32 v129, s57, v53
    v_lshlrev_b32 v130, 16, v57
    v_and_b32 v131, s57, v57
    v_lshlrev_b32 v132, 16, v61
    v_and_b32 v133, s57, v61
    v_lshlrev_b32 v134, 16, v65
    v_and_b32 v135, s57, v65
    v_lshlrev_b32 v136, 16, v69
    v_and_b32 v137, s57, v69
    v_lshlrev_b32 v138, 16, v73
    v_and_b32 v139, s57, v73
    v_lshlrev_b32 v140, 16, v77
    v_and_b32 v141, s57, v77
    v_lshlrev_b32 v142, 16, v81
    v_and_b32 v143, s57, v81
    v_lshlrev_b32 v144, 16, v85
    v_and_b32 v145, s57, v85
    v_lshlrev_b32 v146, 16, v89
    v_and_b32 v147, s57, v89
    v_lshlrev_b32 v148, 16, v93
    v_and_b32 v149, s57, v93
    v_pk_mul_f32 v[150:151], v[110:111], v[128:129]
    v_pk_mul_f32 v[152:153], v[110:111], v[130:131]
    v_pk_mul_f32 v[154:155], v[110:111], v[132:133]
    v_pk_mul_f32 v[156:157], v[110:111], v[134:135]
    v_pk_fma_f32 v[150:151], v[108:109], v[130:131], v[150:151]
    v_pk_fma_f32 v[152:153], v[108:109], v[132:133], v[152:153]
    v_pk_fma_f32 v[154:155], v[108:109], v[134:135], v[154:155]
    v_pk_fma_f32 v[156:157], v[108:109], v[136:137], v[156:157]
    v_pk_fma_f32 v[150:151], v[106:107], v[132:133], v[150:151]
    v_pk_fma_f32 v[152:153], v[106:107], v[134:135], v[152:153]
    v_pk_fma_f32 v[154:155], v[106:107], v[136:137], v[154:155]
    v_pk_fma_f32 v[156:157], v[106:107], v[138:139], v[156:157]
    v_pk_fma_f32 v[150:151], v[104:105], v[134:135], v[150:151]
    v_pk_fma_f32 v[152:153], v[104:105], v[136:137], v[152:153]
    v_pk_fma_f32 v[154:155], v[104:105], v[138:139], v[154:155]
    v_pk_fma_f32 v[156:157], v[104:105], v[140:141], v[156:157]
    v_pk_mul_f32 v[150:151], v[150:151], v[142:143]
    v_pk_mul_f32 v[152:153], v[152:153], v[144:145]
    v_pk_mul_f32 v[154:155], v[154:155], v[146:147]
    v_pk_mul_f32 v[156:157], v[156:157], v[148:149]
    v_cvt_pk_bf16_f32 v164, v156, v154
    v_cvt_pk_bf16_f32 v165, v152, v150
    ds_write_b64 v7, v[164:165] offset:1056
    v_cvt_pk_bf16_f32 v166, v157, v155
    v_cvt_pk_bf16_f32 v167, v153, v151
    ds_write_b64 v7, v[166:167] offset:1584
    v_lshlrev_b32 v128, 16, v54
    v_and_b32 v129, s57, v54
    v_lshlrev_b32 v130, 16, v58
    v_and_b32 v131, s57, v58
    v_lshlrev_b32 v132, 16, v62
    v_and_b32 v133, s57, v62
    v_lshlrev_b32 v134, 16, v66
    v_and_b32 v135, s57, v66
    v_lshlrev_b32 v136, 16, v70
    v_and_b32 v137, s57, v70
    v_lshlrev_b32 v138, 16, v74
    v_and_b32 v139, s57, v74
    v_lshlrev_b32 v140, 16, v78
    v_and_b32 v141, s57, v78
    v_lshlrev_b32 v142, 16, v82
    v_and_b32 v143, s57, v82
    v_lshlrev_b32 v144, 16, v86
    v_and_b32 v145, s57, v86
    v_lshlrev_b32 v146, 16, v90
    v_and_b32 v147, s57, v90
    v_lshlrev_b32 v148, 16, v94
    v_and_b32 v149, s57, v94
    v_pk_mul_f32 v[150:151], v[118:119], v[128:129]
    v_pk_mul_f32 v[152:153], v[118:119], v[130:131]
    v_pk_mul_f32 v[154:155], v[118:119], v[132:133]
    v_pk_mul_f32 v[156:157], v[118:119], v[134:135]
    v_pk_fma_f32 v[150:151], v[116:117], v[130:131], v[150:151]
    v_pk_fma_f32 v[152:153], v[116:117], v[132:133], v[152:153]
    v_pk_fma_f32 v[154:155], v[116:117], v[134:135], v[154:155]
    v_pk_fma_f32 v[156:157], v[116:117], v[136:137], v[156:157]
    v_pk_fma_f32 v[150:151], v[114:115], v[132:133], v[150:151]
    v_pk_fma_f32 v[152:153], v[114:115], v[134:135], v[152:153]
    v_pk_fma_f32 v[154:155], v[114:115], v[136:137], v[154:155]
    v_pk_fma_f32 v[156:157], v[114:115], v[138:139], v[156:157]
    v_pk_fma_f32 v[150:151], v[112:113], v[134:135], v[150:151]
    v_pk_fma_f32 v[152:153], v[112:113], v[136:137], v[152:153]
    v_pk_fma_f32 v[154:155], v[112:113], v[138:139], v[154:155]
    v_pk_fma_f32 v[156:157], v[112:113], v[140:141], v[156:157]
    v_pk_mul_f32 v[150:151], v[150:151], v[142:143]
    v_pk_mul_f32 v[152:153], v[152:153], v[144:145]
    v_pk_mul_f32 v[154:155], v[154:155], v[146:147]
    v_pk_mul_f32 v[156:157], v[156:157], v[148:149]
    v_cvt_pk_bf16_f32 v160, v156, v154
    v_cvt_pk_bf16_f32 v161, v152, v150
    ds_write_b64 v7, v[160:161] offset:2112
    v_cvt_pk_bf16_f32 v162, v157, v155
    v_cvt_pk_bf16_f32 v163, v153, v151
    ds_write_b64 v7, v[162:163] offset:2640
    v_lshlrev_b32 v128, 16, v55
    v_and_b32 v129, s57, v55
    v_lshlrev_b32 v130, 16, v59
    v_and_b32 v131, s57, v59
    v_lshlrev_b32 v132, 16, v63
    v_and_b32 v133, s57, v63
    v_lshlrev_b32 v134, 16, v67
    v_and_b32 v135, s57, v67
    v_lshlrev_b32 v136, 16, v71
    v_and_b32 v137, s57, v71
    v_lshlrev_b32 v138, 16, v75
    v_and_b32 v139, s57, v75
    v_lshlrev_b32 v140, 16, v79
    v_and_b32 v141, s57, v79
    v_lshlrev_b32 v142, 16, v83
    v_and_b32 v143, s57, v83
    v_lshlrev_b32 v144, 16, v87
    v_and_b32 v145, s57, v87
    v_lshlrev_b32 v146, 16, v91
    v_and_b32 v147, s57, v91
    v_lshlrev_b32 v148, 16, v95
    v_and_b32 v149, s57, v95
    v_pk_mul_f32 v[150:151], v[126:127], v[128:129]
    v_pk_mul_f32 v[152:153], v[126:127], v[130:131]
    v_pk_mul_f32 v[154:155], v[126:127], v[132:133]
    v_pk_mul_f32 v[156:157], v[126:127], v[134:135]
    v_pk_fma_f32 v[150:151], v[124:125], v[130:131], v[150:151]
    v_pk_fma_f32 v[152:153], v[124:125], v[132:133], v[152:153]
    v_pk_fma_f32 v[154:155], v[124:125], v[134:135], v[154:155]
    v_pk_fma_f32 v[156:157], v[124:125], v[136:137], v[156:157]
    v_pk_fma_f32 v[150:151], v[122:123], v[132:133], v[150:151]
    v_pk_fma_f32 v[152:153], v[122:123], v[134:135], v[152:153]
    v_pk_fma_f32 v[154:155], v[122:123], v[136:137], v[154:155]
    v_pk_fma_f32 v[156:157], v[122:123], v[138:139], v[156:157]
    v_pk_fma_f32 v[150:151], v[120:121], v[134:135], v[150:151]
    v_pk_fma_f32 v[152:153], v[120:121], v[136:137], v[152:153]
    v_pk_fma_f32 v[154:155], v[120:121], v[138:139], v[154:155]
    v_pk_fma_f32 v[156:157], v[120:121], v[140:141], v[156:157]
    v_pk_mul_f32 v[150:151], v[150:151], v[142:143]
    v_pk_mul_f32 v[152:153], v[152:153], v[144:145]
    v_pk_mul_f32 v[154:155], v[154:155], v[146:147]
    v_pk_mul_f32 v[156:157], v[156:157], v[148:149]
    v_cvt_pk_bf16_f32 v164, v156, v154
    v_cvt_pk_bf16_f32 v165, v152, v150
    ds_write_b64 v7, v[164:165] offset:3168
    v_cvt_pk_bf16_f32 v166, v157, v155
    v_cvt_pk_bf16_f32 v167, v153, v151
    ds_write_b64 v7, v[166:167] offset:3696
    v_lshrrev_b32 v12, 5, v1
    v_mul_u32_u24 v12, 528, v12
    v_and_b32 v13, 31, v1
    v_lshlrev_b32 v13, 4, v13
    v_add_u32 v12, v12, v13
    s_mul_i32 s6, s3, 17936
    s_add_u32 s6, s6, 9216
    v_add_u32 v12, s6, v12
    s_add_u32 s36, s30, 0x280000
    s_addc_u32 s37, s31, 0
    s_mov_b32 s38, 0x280000
    s_mov_b32 s39, 0x00020000
    v_lshrrev_b32 v14, 5, v1
    v_lshlrev_b32 v14, 12, v14
    v_add_u32 v14, v14, v13
    s_lshl_b32 s6, s73, 6
    s_lshl_b32 s7, s3, 3
    s_add_u32 s6, s6, s7
    s_lshl_b32 s6, s6, 12
    s_lshl_b32 s7, s72, 9
    s_sub_u32 s7, 3584, s7
    s_add_u32 s6, s6, s7
    v_add_u32 v14, s6, v14
    s_waitcnt lgkmcnt(0)
    s_barrier
    ds_read_b128 v[64:67], v12 offset:0
    ds_read_b128 v[68:71], v12 offset:1056
    ds_read_b128 v[72:75], v12 offset:2112
    ds_read_b128 v[76:79], v12 offset:3168
    s_waitcnt lgkmcnt(0)
    s_mov_b32 s6, 0
    buffer_store_dwordx4 v[64:67], v14, s[36:39], s6 offen sc1
    s_add_u32 s6, s6, 8192
    buffer_store_dwordx4 v[68:71], v14, s[36:39], s6 offen sc1
    s_add_u32 s6, s6, 8192
    buffer_store_dwordx4 v[72:75], v14, s[36:39], s6 offen sc1
    s_add_u32 s6, s6, 8192
    buffer_store_dwordx4 v[76:79], v14, s[36:39], s6 offen sc1
    s_mov_b32 s52, s16
    s_mov_b32 s53, s17
    s_mov_b32 s54, 0x280000
    s_mov_b32 s55, 0x00020000
    s_add_u32 m0, s60, 448
    s_add_u32 s6, s59, 0
    buffer_load_dwordx4 v10, s[52:55], s6 offen  lds
    s_add_u32 m0, s60, 1472
    s_add_u32 s6, s59, 1024
    buffer_load_dwordx4 v10, s[52:55], s6 offen  lds
    s_add_u32 m0, s60, 2496
    s_add_u32 s6, s59, 2048
    buffer_load_dwordx4 v10, s[52:55], s6 offen  lds
    s_add_u32 m0, s60, 3520
    s_add_u32 s6, s59, 3072
    buffer_load_dwordx4 v10, s[52:55], s6 offen  lds
    v_mov_b32 v13, 0
    buffer_load_dwordx4 v[16:19], v13, s[52:55], s59 offen
    s_lshr_b32 s6, s3, 1
    s_cmp_eq_u32 s6, 1
    s_cselect_b32 s58, s65, s64
    s_cmp_eq_u32 s6, 2
    s_cselect_b32 s58, s66, s58
    s_cmp_eq_u32 s6, 3
    s_cselect_b32 s58, s67, s58
    s_and_b32 s6, s3, 1
    s_lshl_b32 s6, s6, 4
    s_lshr_b32 s58, s58, s6
    s_lshl_b32 s58, s58, 16
    s_waitcnt vmcnt(5)
    v_readfirstlane_b32 s44, v250
    s_add_u32 s44, s44, 1
    s_barrier
    s_cmp_lg_u32 s3, 0
    s_cbranch_scc1 AF_47
    s_lshl_b32 s6, s73, 3
    s_add_u32 s6, s6, s72
    s_lshl_b32 s6, s6, 7
    s_add_u32 s6, s6, 24576
    v_mov_b32 v12, s6
    v_mov_b32 v13, s44
    s_mov_b64 exec, 1
    buffer_store_dword v13, v12, s[48:51], 0 offen sc1
    s_mov_b64 exec, -1
AF_47:
    s_cmp_lg_u32 s3, 0
    s_cbranch_scc1 AP_48
    s_lshl_b32 s6, s73, 10
    s_add_u32 s6, s6, 24576
    v_lshlrev_b32 v12, 7, v1
    v_add_u32 v12, s6, v12
    s_mov_b32 s45, 0
    s_mov_b64 exec, 0xff
PF_49:
    buffer_load_dword v4, v12, s[48:51], 0 offen sc1
    s_waitcnt vmcnt(0)
    v_cmp_ne_u32 vcc, s44, v4
    s_add_u32 s45, s45, 1
    s_nop 3
    s_cbranch_vccz PF_50
    s_cmp_gt_u32 s45, 1048576
    s_cbranch_scc1 PF_50
    s_sleep 2
    s_branch PF_49
PF_50:
    s_mov_b64 exec, -1
    s_cmp_lg_u32 s72, 0
    s_cbranch_scc1 EU_51
    v_mov_b32 v13, s44
    s_mov_b64 exec, 1
    buffer_store_dword v13, v251, s[48:51], 0 offen sc1
    s_mov_b64 exec, -1
EU_51:
AP_48:
    s_waitcnt lgkmcnt(0)
    s_barrier
    s_add_u32 m0, s60, 9216
    s_add_u32 s6, s59, 0
    buffer_load_dwordx4 v10, s[36:39], s6 offen sc1 lds
    s_add_u32 m0, s60, 10240
    s_add_u32 s6, s59, 1024
    buffer_load_dwordx4 v10, s[36:39], s6 offen sc1 lds
    s_add_u32 m0, s60, 11264
    s_add_u32 s6, s59, 2048
    buffer_load_dwordx4 v10, s[36:39], s6 offen sc1 lds
    s_add_u32 m0, s60, 12288
    s_add_u32 s6, s59, 3072
    buffer_load_dwordx4 v10, s[36:39], s6 offen sc1 lds
    s_mov_b64 exec, 0x1f
    ds_write_b128 v23, v[28:31] offset:13312
    s_mov_b64 exec, 0xf
    ds_write_b128 v23, v[28:31] offset:17792
    s_mov_b64 exec, -1
    s_mov_b32 s32, s8
    s_mov_b32 s33, s9
    s_mov_b32 s34, 0x280000
    s_mov_b32 s35, 0x00020000
    s_and_b32 s6, s3, 3
    s_lshl_b32 s6, s6, 6
    s_lshl_b32 s7, s72, 8
    s_add_u32 s6, s6, s7
    v_add_u32 v14, s6, v1
    v_mul_u32_u24 v14, 1280, v14
    s_lshl_b32 s61, s73, 7
    v_add_u32 v14, s61, v14
    v_mov_b32 v13, 0x80000000
    s_cmp_lt_u32 s3, 4
    s_cselect_b64 vcc, -1, 0
    v_cndmask_b32 v14, v13, v14, vcc
    buffer_load_dword v243, v14, s[32:35], 0 offen
    s_lshl_b32 s6, s3, 8
    v_add_u32 v9, s6, v1
    s_lshl_b32 s61, s62, 1
    v_mul_u32_u24 v8, 1280, v9
    v_add_u32 v8, s61, v8
    s_waitcnt vmcnt(5)
    v_lshlrev_b32 v21, 16, v16
    v_add_f32 v21, s58, v21
    v_cvt_pk_bf16_f32 v21, v21, v21
    v_mov_b32 v22, s60
    s_mov_b64 exec, 1
    ds_write_b16 v22, v21 offset:448
    s_mov_b64 exec, -1
    s_waitcnt lgkmcnt(0)
    ds_read_b128 v[64:67], v23 offset:448
    ds_read_b32 v68, v23 offset:444
    ds_read_b128 v[72:75], v23 offset:1472
    ds_read_b32 v76, v23 offset:1468
    ds_read_b128 v[80:83], v23 offset:2496
    ds_read_b32 v84, v23 offset:2492
    ds_read_b128 v[88:91], v23 offset:3520
    ds_read_b32 v92, v23 offset:3516
    s_waitcnt lgkmcnt(6)
    v_alignbit_b32 v71, v67, v66, 16
    v_alignbit_b32 v70, v66, v65, 16
    v_alignbit_b32 v69, v65, v64, 16
    v_alignbit_b32 v68, v64, v68, 16
    ds_write_b128 v23, v[68:71] offset:5088
    s_waitcnt lgkmcnt(4)
    v_alignbit_b32 v79, v75, v74, 16
    v_alignbit_b32 v78, v74, v73, 16
    v_alignbit_b32 v77, v73, v72, 16
    v_alignbit_b32 v76, v72, v76, 16
    ds_write_b128 v23, v[76:79] offset:6112
    s_waitcnt lgkmcnt(2)
    v_alignbit_b32 v87, v83, v82, 16
    v_alignbit_b32 v86, v82, v81, 16
    v_alignbit_b32 v85, v81, v80, 16
    v_alignbit_b32 v84, v80, v84, 16
    ds_write_b128 v23, v[84:87] offset:7136
    s_waitcnt lgkmcnt(0)
    v_alignbit_b32 v95, v91, v90, 16
    v_alignbit_b32 v94, v90, v89, 16
    v_alignbit_b32 v93, v89, v88, 16
    v_alignbit_b32 v92, v88, v92, 16
    ds_write_b128 v23, v[92:95] offset:8160
    v_and_b32 v10, 15, v1
    v_lshrrev_b32 v11, 4, v1
    v_lshrrev_b32 v12, 1, v10
    v_lshlrev_b32 v12, 6, v12
    v_lshlrev_b32 v13, 4, v11
    v_add_u32 v12, v12, v13
    v_and_b32 v13, 1, v10
    v_mov_b32 v14, 4640
    v_mov_b32 v15, 0
    v_cmp_eq_u32 vcc, 1, v13
    v_lshrrev_b32 v13, 1, v10
    v_and_b32 v13, 1, v13
    v_cndmask_b32 v14, v14, v15, vcc
    v_add3_u32 v2, v12, v14, s60
    v_lshlrev_b32 v12, 3, v13
    v_lshrrev_b32 v14, 2, v10
    v_lshlrev_b32 v14, 4, v14
    v_add_u32 v12, v12, v14
    v_lshlrev_b32 v14, 4, v11
    v_sub_u32 v12, v14, v12
    v_add_u32 v12, 56, v12
    v_mov_b32 v14, 13696
    v_mov_b32 v15, 9216
    v_cndmask_b32 v14, v14, v15, vcc
    v_add3_u32 v3, v12, v14, s60
    v_mov_b32 v32, 0
    v_mov_b32 v33, 0
    v_mov_b32 v34, 0
    v_mov_b32 v35, 0
    v_mov_b32 v36, 0
    v_mov_b32 v37, 0
    v_mov_b32 v38, 0
    v_mov_b32 v39, 0
    v_mov_b32 v40, 0
    v_mov_b32 v41, 0
    v_mov_b32 v42, 0
    v_mov_b32 v43, 0
    v_mov_b32 v44, 0
    v_mov_b32 v45, 0
    v_mov_b32 v46, 0
    v_mov_b32 v47, 0
    v_mov_b32 v48, 0
    v_mov_b32 v49, 0
    v_mov_b32 v50, 0
    v_mov_b32 v51, 0
    v_mov_b32 v52, 0
    v_mov_b32 v53, 0
    v_mov_b32 v54, 0
    v_mov_b32 v55, 0
    v_mov_b32 v56, 0
    v_mov_b32 v57, 0
    v_mov_b32 v58, 0
    v_mov_b32 v59, 0
    v_mov_b32 v60, 0
    v_mov_b32 v61, 0
    v_mov_b32 v62, 0
    v_mov_b32 v63, 0
    s_waitcnt vmcnt(1)
    ds_read_b32 v96, v23 offset:9220
    ds_read_b32 v97, v23 offset:9224
    ds_read_b32 v98, v23 offset:9228
    ds_read_b32 v99, v23 offset:9232
    ds_read_b32 v100, v23 offset:10244
    ds_read_b32 v101, v23 offset:10248
    ds_read_b32 v102, v23 offset:10252
    ds_read_b32 v103, v23 offset:10256
    ds_read_b32 v104, v23 offset:11268
    ds_read_b32 v105, v23 offset:11272
    ds_read_b32 v106, v23 offset:11276
    ds_read_b32 v107, v23 offset:11280
    ds_read_b32 v108, v23 offset:12292
    ds_read_b32 v109, v23 offset:12296
    ds_read_b32 v110, v23 offset:12300
    ds_read_b32 v111, v23 offset:12304
    s_waitcnt lgkmcnt(12)
    ds_write_b128 v23, v[96:99] offset:13696
    s_waitcnt lgkmcnt(8)
    ds_write_b128 v23, v[100:103] offset:14720
    s_waitcnt lgkmcnt(4)
    ds_write_b128 v23, v[104:107] offset:15744
    s_waitcnt lgkmcnt(0)
    ds_write_b128 v23, v[108:111] offset:16768
    s_waitcnt lgkmcnt(0)
    ds_read_b128 v[64:67], v2 offset:0
    ds_read_b64 v[96:97], v3 offset:3584
    ds_read_b64 v[98:99], v3 offset:3592
    ds_read_b128 v[68:71], v2 offset:512
    ds_read_b64 v[100:101], v3 offset:3072
    ds_read_b64 v[102:103], v3 offset:3080
    ds_read_b128 v[72:75], v2 offset:1024
    ds_read_b64 v[104:105], v3 offset:2560
    ds_read_b64 v[106:107], v3 offset:2568
    ds_read_b128 v[76:79], v2 offset:1536
    ds_read_b64 v[108:109], v3 offset:2048
    ds_read_b64 v[110:111], v3 offset:2056
    ds_read_b128 v[80:83], v2 offset:2048
    ds_read_b64 v[112:113], v3 offset:1536
    ds_read_b64 v[114:115], v3 offset:1544
    ds_read_b128 v[84:87], v2 offset:2560
    ds_read_b64 v[116:117], v3 offset:1024
    ds_read_b64 v[118:119], v3 offset:1032
    ds_read_b128 v[88:91], v2 offset:3072
    ds_read_b64 v[120:121], v3 offset:512
    ds_read_b64 v[122:123], v3 offset:520
    ds_read_b128 v[92:95], v2 offset:3584
    ds_read_b64 v[124:125], v3 offset:0
    ds_read_b64 v[126:127], v3 offset:8
    v_add_u32 v2, 64, v2
    v_add_u32 v3, 64, v3
    s_mov_b32 s40, 0
A2L_52:
    s_waitcnt lgkmcnt(0)
    v_mfma_f32_16x16x32_bf16 v[32:35], v[64:67], v[96:99], v[32:35]
    ds_read_b128 v[128:131], v2 offset:0
    v_mfma_f32_16x16x32_bf16 v[36:39], v[64:67], v[100:103], v[36:39]
    ds_read_b64 v[160:161], v3 offset:3584
    v_mfma_f32_16x16x32_bf16 v[36:39], v[68:71], v[96:99], v[36:39]
    ds_read_b64 v[162:163], v3 offset:3592
    v_mfma_f32_16x16x32_bf16 v[40:43], v[64:67], v[104:107], v[40:43]
    ds_read_b128 v[132:135], v2 offset:512
    v_mfma_f32_16x16x32_bf16 v[40:43], v[68:71], v[100:103], v[40:43]
    ds_read_b64 v[164:165], v3 offset:3072
    v_mfma_f32_16x16x32_bf16 v[40:43], v[72:75], v[96:99], v[40:43]
    ds_read_b64 v[166:167], v3 offset:3080
    v_mfma_f32_16x16x32_bf16 v[44:47], v[64:67], v[108:111], v[44:47]
    ds_read_b128 v[136:139], v2 offset:1024
    v_mfma_f32_16x16x32_bf16 v[44:47], v[68:71], v[104:107], v[44:47]
    ds_read_b64 v[168:169], v3 offset:2560
    v_mfma_f32_16x16x32_bf16 v[44:47], v[72:75], v[100:103], v[44:47]
    ds_read_b64 v[170:171], v3 offset:2568
    v_mfma_f32_16x16x32_bf16 v[44:47], v[76:79], v[96:99], v[44:47]
    ds_read_b128 v[140:143], v2 offset:1536
    v_mfma_f32_16x16x32_bf16 v[48:51], v[64:67], v[112:115], v[48:51]
    ds_read_b64 v[172:173], v3 offset:2048
    v_mfma_f32_16x16x32_bf16 v[48:51], v[68:71], v[108:111], v[48:51]
    ds_read_b64 v[174:175], v3 offset:2056
    v_mfma_f32_16x16x32_bf16 v[48:51], v[72:75], v[104:107], v[48:51]
    ds_read_b128 v[144:147], v2 offset:2048
    v_mfma_f32_16x16x32_bf16 v[48:51], v[76:79], v[100:103], v[48:51]
    ds_read_b64 v[176:177], v3 offset:1536
    v_mfma_f32_16x16x32_bf16 v[48:51], v[80:83], v[96:99], v[48:51]
    ds_read_b64 v[178:179], v3 offset:1544
    v_mfma_f32_16x16x32_bf16 v[52:55], v[64:67], v[116:119], v[52:55]
    ds_read_b128 v[148:151], v2 offset:2560
    v_mfma_f32_16x16x32_bf16 v[52:55], v[68:71], v[112:115], v[52:55]
    ds_read_b64 v[180:181], v3 offset:1024
    v_mfma_f32_16x16x32_bf16 v[52:55], v[72:75], v[108:111], v[52:55]
    ds_read_b64 v[182:183], v3 offset:1032
    v_mfma_f32_16x16x32_bf16 v[52:55], v[76:79], v[104:107], v[52:55]
    ds_read_b128 v[152:155], v2 offset:3072
    v_mfma_f32_16x16x32_bf16 v[52:55], v[80:83], v[100:103], v[52:55]
    ds_read_b64 v[184:185], v3 offset:512
    v_mfma_f32_16x16x32_bf16 v[52:55], v[84:87], v[96:99], v[52:55]
    ds_read_b64 v[186:187], v3 offset:520
    v_mfma_f32_16x16x32_bf16 v[56:59], v[64:67], v[120:123], v[56:59]
    ds_read_b128 v[156:159], v2 offset:3584
    v_mfma_f32_16x16x32_bf16 v[56:59], v[68:71], v[116:119], v[56:59]
    ds_read_b64 v[188:189], v3 offset:0
    v_mfma_f32_16x16x32_bf16 v[56:59], v[72:75], v[112:115], v[56:59]
    ds_read_b64 v[190:191], v3 offset:8
    v_mfma_f32_16x16x32_bf16 v[56:59], v[76:79], v[108:111], v[56:59]
    v_add_u32 v2, 64, v2
    v_mfma_f32_16x16x32_bf16 v[56:59], v[80:83], v[104:107], v[56:59]
    v_add_u32 v3, 64, v3
    v_mfma_f32_16x16x32_bf16 v[56:59], v[84:87], v[100:103], v[56:59]
    v_mfma_f32_16x16x32_bf16 v[56:59], v[88:91], v[96:99], v[56:59]
    v_mfma_f32_16x16x32_bf16 v[60:63], v[64:67], v[124:127], v[60:63]
    v_mfma_f32_16x16x32_bf16 v[60:63], v[68:71], v[120:123], v[60:63]
    v_mfma_f32_16x16x32_bf16 v[60:63], v[72:75], v[116:119], v[60:63]
    v_mfma_f32_16x16x32_bf16 v[60:63], v[76:79], v[112:115], v[60:63]
    v_mfma_f32_16x16x32_bf16 v[60:63], v[80:83], v[108:111], v[60:63]
    v_mfma_f32_16x16x32_bf16 v[60:63], v[84:87], v[104:107], v[60:63]
    v_mfma_f32_16x16x32_bf16 v[60:63], v[88:91], v[100:103], v[60:63]
    v_mfma_f32_16x16x32_bf16 v[60:63], v[92:95], v[96:99], v[60:63]
    s_waitcnt lgkmcnt(0)
    s_mul_i32 s6, s40, 81920
    s_cmp_lg_u32 s40, 0
    s_cbranch_scc1 QL_54
    buffer_load_dwordx4 v[192:195], v8, s[32:35], s6 offen
QL_54:
    s_cmp_lg_u32 s40, 1
    s_cbranch_scc1 QL_55
    buffer_load_dwordx4 v[196:199], v8, s[32:35], s6 offen
QL_55:
    s_cmp_lg_u32 s40, 2
    s_cbranch_scc1 QL_56
    buffer_load_dwordx4 v[200:203], v8, s[32:35], s6 offen
QL_56:
    s_cmp_lg_u32 s40, 3
    s_cbranch_scc1 QL_57
    buffer_load_dwordx4 v[204:207], v8, s[32:35], s6 offen
QL_57:
    s_cmp_eq_u32 s40, 3
    s_cbranch_scc1 A2E_53
    v_mfma_f32_16x16x32_bf16 v[32:35], v[128:131], v[160:163], v[32:35]
    ds_read_b128 v[64:67], v2 offset:0
    v_mfma_f32_16x16x32_bf16 v[36:39], v[128:131], v[164:167], v[36:39]
    ds_read_b64 v[96:97], v3 offset:3584
    v_mfma_f32_16x16x32_bf16 v[36:39], v[132:135], v[160:163], v[36:39]
    ds_read_b64 v[98:99], v3 offset:3592
    v_mfma_f32_16x16x32_bf16 v[40:43], v[128:131], v[168:171], v[40:43]
    ds_read_b128 v[68:71], v2 offset:512
    v_mfma_f32_16x16x32_bf16 v[40:43], v[132:135], v[164:167], v[40:43]
    ds_read_b64 v[100:101], v3 offset:3072
    v_mfma_f32_16x16x32_bf16 v[40:43], v[136:139], v[160:163], v[40:43]
    ds_read_b64 v[102:103], v3 offset:3080
    v_mfma_f32_16x16x32_bf16 v[44:47], v[128:131], v[172:175], v[44:47]
    ds_read_b128 v[72:75], v2 offset:1024
    v_mfma_f32_16x16x32_bf16 v[44:47], v[132:135], v[168:171], v[44:47]
    ds_read_b64 v[104:105], v3 offset:2560
    v_mfma_f32_16x16x32_bf16 v[44:47], v[136:139], v[164:167], v[44:47]
    ds_read_b64 v[106:107], v3 offset:2568
    v_mfma_f32_16x16x32_bf16 v[44:47], v[140:143], v[160:163], v[44:47]
    ds_read_b128 v[76:79], v2 offset:1536
    v_mfma_f32_16x16x32_bf16 v[48:51], v[128:131], v[176:179], v[48:51]
    ds_read_b64 v[108:109], v3 offset:2048
    v_mfma_f32_16x16x32_bf16 v[48:51], v[132:135], v[172:175], v[48:51]
    ds_read_b64 v[110:111], v3 offset:2056
    v_mfma_f32_16x16x32_bf16 v[48:51], v[136:139], v[168:171], v[48:51]
    ds_read_b128 v[80:83], v2 offset:2048
    v_mfma_f32_16x16x32_bf16 v[48:51], v[140:143], v[164:167], v[48:51]
    ds_read_b64 v[112:113], v3 offset:1536
    v_mfma_f32_16x16x32_bf16 v[48:51], v[144:147], v[160:163], v[48:51]
    ds_read_b64 v[114:115], v3 offset:1544
    v_mfma_f32_16x16x32_bf16 v[52:55], v[128:131], v[180:183], v[52:55]
    ds_read_b128 v[84:87], v2 offset:2560
    v_mfma_f32_16x16x32_bf16 v[52:55], v[132:135], v[176:179], v[52:55]
    ds_read_b64 v[116:117], v3 offset:1024
    v_mfma_f32_16x16x32_bf16 v[52:55], v[136:139], v[172:175], v[52:55]
    ds_read_b64 v[118:119], v3 offset:1032
    v_mfma_f32_16x16x32_bf16 v[52:55], v[140:143], v[168:171], v[52:55]
    ds_read_b128 v[88:91], v2 offset:3072
    v_mfma_f32_16x16x32_bf16 v[52:55], v[144:147], v[164:167], v[52:55]
    ds_read_b64 v[120:121], v3 offset:512
    v_mfma_f32_16x16x32_bf16 v[52:55], v[148:151], v[160:163], v[52:55]
    ds_read_b64 v[122:123], v3 offset:520
    v_mfma_f32_16x16x32_bf16 v[56:59], v[128:131], v[184:187], v[56:59]
    ds_read_b128 v[92:95], v2 offset:3584
    v_mfma_f32_16x16x32_bf16 v[56:59], v[132:135], v[180:183], v[56:59]
    ds_read_b64 v[124:125], v3 offset:0
    v_mfma_f32_16x16x32_bf16 v[56:59], v[136:139], v[176:179], v[56:59]
    ds_read_b64 v[126:127], v3 offset:8
    v_mfma_f32_16x16x32_bf16 v[56:59], v[140:143], v[172:175], v[56:59]
    v_add_u32 v2, 64, v2
    v_mfma_f32_16x16x32_bf16 v[56:59], v[144:147], v[168:171], v[56:59]
    v_add_u32 v3, 64, v3
    v_mfma_f32_16x16x32_bf16 v[56:59], v[148:151], v[164:167], v[56:59]
    v_mfma_f32_16x16x32_bf16 v[56:59], v[152:155], v[160:163], v[56:59]
    v_mfma_f32_16x16x32_bf16 v[60:63], v[128:131], v[188:191], v[60:63]
    v_mfma_f32_16x16x32_bf16 v[60:63], v[132:135], v[184:187], v[60:63]
    v_mfma_f32_16x16x32_bf16 v[60:63], v[136:139], v[180:183], v[60:63]
    v_mfma_f32_16x16x32_bf16 v[60:63], v[140:143], v[176:179], v[60:63]
    v_mfma_f32_16x16x32_bf16 v[60:63], v[144:147], v[172:175], v[60:63]
    v_mfma_f32_16x16x32_bf16 v[60:63], v[148:151], v[168:171], v[60:63]
    v_mfma_f32_16x16x32_bf16 v[60:63], v[152:155], v[164:167], v[60:63]
    v_mfma_f32_16x16x32_bf16 v[60:63], v[156:159], v[160:163], v[60:63]
    s_add_u32 s40, s40, 1
    s_branch A2L_52
A2E_53:
    v_mfma_f32_16x16x32_bf16 v[32:35], v[128:131], v[160:163], v[32:35]
    v_mfma_f32_16x16x32_bf16 v[36:39], v[128:131], v[164:167], v[36:39]
    v_mfma_f32_16x16x32_bf16 v[36:39], v[132:135], v[160:163], v[36:39]
    v_mfma_f32_16x16x32_bf16 v[40:43], v[128:131], v[168:171], v[40:43]
    v_mfma_f32_16x16x32_bf16 v[40:43], v[132:135], v[164:167], v[40:43]
    v_mfma_f32_16x16x32_bf16 v[40:43], v[136:139], v[160:163], v[40:43]
    v_mfma_f32_16x16x32_bf16 v[44:47], v[128:131], v[172:175], v[44:47]
    v_mfma_f32_16x16x32_bf16 v[44:47], v[132:135], v[168:171], v[44:47]
    v_mfma_f32_16x16x32_bf16 v[44:47], v[136:139], v[164:167], v[44:47]
    v_mfma_f32_16x16x32_bf16 v[44:47], v[140:143], v[160:163], v[44:47]
    v_mfma_f32_16x16x32_bf16 v[48:51], v[128:131], v[176:179], v[48:51]
    v_mfma_f32_16x16x32_bf16 v[48:51], v[132:135], v[172:175], v[48:51]
    v_mfma_f32_16x16x32_bf16 v[48:51], v[136:139], v[168:171], v[48:51]
    v_mfma_f32_16x16x32_bf16 v[48:51], v[140:143], v[164:167], v[48:51]
    v_mfma_f32_16x16x32_bf16 v[48:51], v[144:147], v[160:163], v[48:51]
    v_mfma_f32_16x16x32_bf16 v[52:55], v[128:131], v[180:183], v[52:55]
    v_mfma_f32_16x16x32_bf16 v[52:55], v[132:135], v[176:179], v[52:55]
    v_mfma_f32_16x16x32_bf16 v[52:55], v[136:139], v[172:175], v[52:55]
    v_mfma_f32_16x16x32_bf16 v[52:55], v[140:143], v[168:171], v[52:55]
    v_mfma_f32_16x16x32_bf16 v[52:55], v[144:147], v[164:167], v[52:55]
    v_mfma_f32_16x16x32_bf16 v[52:55], v[148:151], v[160:163], v[52:55]
    v_mfma_f32_16x16x32_bf16 v[56:59], v[128:131], v[184:187], v[56:59]
    v_mfma_f32_16x16x32_bf16 v[56:59], v[132:135], v[180:183], v[56:59]
    v_mfma_f32_16x16x32_bf16 v[56:59], v[136:139], v[176:179], v[56:59]
    v_mfma_f32_16x16x32_bf16 v[56:59], v[140:143], v[172:175], v[56:59]
    v_mfma_f32_16x16x32_bf16 v[56:59], v[144:147], v[168:171], v[56:59]
    v_mfma_f32_16x16x32_bf16 v[56:59], v[148:151], v[164:167], v[56:59]
    v_mfma_f32_16x16x32_bf16 v[56:59], v[152:155], v[160:163], v[56:59]
    v_mfma_f32_16x16x32_bf16 v[60:63], v[128:131], v[188:191], v[60:63]
    v_mfma_f32_16x16x32_bf16 v[60:63], v[132:135], v[184:187], v[60:63]
    v_mfma_f32_16x16x32_bf16 v[60:63], v[136:139], v[180:183], v[60:63]
    v_mfma_f32_16x16x32_bf16 v[60:63], v[140:143], v[176:179], v[60:63]
    v_mfma_f32_16x16x32_bf16 v[60:63], v[144:147], v[172:175], v[60:63]
    v_mfma_f32_16x16x32_bf16 v[60:63], v[148:151], v[168:171], v[60:63]
    v_mfma_f32_16x16x32_bf16 v[60:63], v[152:155], v[164:167], v[60:63]
    v_mfma_f32_16x16x32_bf16 v[60:63], v[156:159], v[160:163], v[60:63]
    v_lshlrev_b32 v12, 5, v11
    v_add_u32 v12, v12, v10
    v_lshlrev_b32 v12, 2, v12
    v_add_u32 v12, s60, v12
    v_cvt_pk_bf16_f32 v64, v32, v33
    v_cvt_pk_bf16_f32 v65, v34, v35
    ds_write_b32 v12, v64 offset:0
    ds_write_b32 v12, v65 offset:64
    v_cvt_pk_bf16_f32 v66, v36, v37
    v_cvt_pk_bf16_f32 v67, v38, v39
    ds_write_b32 v12, v66 offset:512
    ds_write_b32 v12, v67 offset:576
    v_cvt_pk_bf16_f32 v68, v40, v41
    v_cvt_pk_bf16_f32 v69, v42, v43
    ds_write_b32 v12, v68 offset:1024
    ds_write_b32 v12, v69 offset:1088
    v_cvt_pk_bf16_f32 v70, v44, v45
    v_cvt_pk_bf16_f32 v71, v46, v47
    ds_write_b32 v12, v70 offset:1536
    ds_write_b32 v12, v71 offset:1600
    v_cvt_pk_bf16_f32 v72, v48, v49
    v_cvt_pk_bf16_f32 v73, v50, v51
    ds_write_b32 v12, v72 offset:2048
    ds_write_b32 v12, v73 offset:2112
    v_cvt_pk_bf16_f32 v74, v52, v53
    v_cvt_pk_bf16_f32 v75, v54, v55
    ds_write_b32 v12, v74 offset:2560
    ds_write_b32 v12, v75 offset:2624
    v_cvt_pk_bf16_f32 v76, v56, v57
    v_cvt_pk_bf16_f32 v77, v58, v59
    ds_write_b32 v12, v76 offset:3072
    ds_write_b32 v12, v77 offset:3136
    v_cvt_pk_bf16_f32 v78, v60, v61
    v_cvt_pk_bf16_f32 v79, v62, v63
    ds_write_b32 v12, v78 offset:3584
    ds_write_b32 v12, v79 offset:3648
    v_lshrrev_b32 v13, 2, v1
    v_and_b32 v13, 3, v13
    v_mul_u32_u24 v13, 17920, v13
    v_lshrrev_b32 v14, 4, v1
    v_lshlrev_b32 v14, 5, v14
    v_and_b32 v15, 3, v1
    v_lshlrev_b32 v15, 3, v15
    v_add3_u32 v13, v13, v14, v15
    s_lshl_b32 s6, s3, 9
    v_add_u32 v13, s6, v13
    v_add_u32 v14, 71680, v13
    s_mov_b32 s36, s26
    s_mov_b32 s37, s27
    s_mov_b32 s38, 0x500000
    s_mov_b32 s39, 0x00020000
    v_mul_u32_u24 v15, 2560, v9
    v_add_u32 v15, s61, v15
    s_waitcnt lgkmcnt(0)
    s_barrier
    ds_read_b64_tr_b16 v[64:65], v13 offset:0
    ds_read_b64_tr_b16 v[66:67], v14 offset:0
    ds_read_b64_tr_b16 v[68:69], v13 offset:128
    ds_read_b64_tr_b16 v[70:71], v14 offset:128
    ds_read_b64_tr_b16 v[72:73], v13 offset:256
    ds_read_b64_tr_b16 v[74:75], v14 offset:256
    ds_read_b64_tr_b16 v[76:77], v13 offset:384
    ds_read_b64_tr_b16 v[78:79], v14 offset:384
    s_waitcnt vmcnt(0)
    s_mov_b32 s6, 0
    s_waitcnt lgkmcnt(6)
    v_lshlrev_b32 v80, 16, v64
    v_and_b32 v81, s57, v64
    v_lshlrev_b32 v82, 16, v192
    v_and_b32 v83, s57, v192
    v_pk_mul_f32 v[80:81], v[80:81], v[82:83]
    v_cvt_pk_bf16_f32 v64, v80, v81
    v_lshlrev_b32 v84, 16, v65
    v_and_b32 v85, s57, v65
    v_lshlrev_b32 v86, 16, v193
    v_and_b32 v87, s57, v193
    v_pk_mul_f32 v[84:85], v[84:85], v[86:87]
    v_cvt_pk_bf16_f32 v65, v84, v85
    v_lshlrev_b32 v80, 16, v66
    v_and_b32 v81, s57, v66
    v_lshlrev_b32 v82, 16, v194
    v_and_b32 v83, s57, v194
    v_pk_mul_f32 v[80:81], v[80:81], v[82:83]
    v_cvt_pk_bf16_f32 v66, v80, v81
    v_lshlrev_b32 v84, 16, v67
    v_and_b32 v85, s57, v67
    v_lshlrev_b32 v86, 16, v195
    v_and_b32 v87, s57, v195
    v_pk_mul_f32 v[84:85], v[84:85], v[86:87]
    v_cvt_pk_bf16_f32 v67, v84, v85
    buffer_store_dwordx4 v[64:67], v15, s[36:39], s6 offen
    s_add_u32 s6, s6, 163840
    s_waitcnt lgkmcnt(4)
    v_lshlrev_b32 v80, 16, v68
    v_and_b32 v81, s57, v68
    v_lshlrev_b32 v82, 16, v196
    v_and_b32 v83, s57, v196
    v_pk_mul_f32 v[80:81], v[80:81], v[82:83]
    v_cvt_pk_bf16_f32 v68, v80, v81
    v_lshlrev_b32 v84, 16, v69
    v_and_b32 v85, s57, v69
    v_lshlrev_b32 v86, 16, v197
    v_and_b32 v87, s57, v197
    v_pk_mul_f32 v[84:85], v[84:85], v[86:87]
    v_cvt_pk_bf16_f32 v69, v84, v85
    v_lshlrev_b32 v80, 16, v70
    v_and_b32 v81, s57, v70
    v_lshlrev_b32 v82, 16, v198
    v_and_b32 v83, s57, v198
    v_pk_mul_f32 v[80:81], v[80:81], v[82:83]
    v_cvt_pk_bf16_f32 v70, v80, v81
    v_lshlrev_b32 v84, 16, v71
    v_and_b32 v85, s57, v71
    v_lshlrev_b32 v86, 16, v199
    v_and_b32 v87, s57, v199
    v_pk_mul_f32 v[84:85], v[84:85], v[86:87]
    v_cvt_pk_bf16_f32 v71, v84, v85
    buffer_store_dwordx4 v[68:71], v15, s[36:39], s6 offen
    s_add_u32 s6, s6, 163840
    s_waitcnt lgkmcnt(2)
    v_lshlrev_b32 v80, 16, v72
    v_and_b32 v81, s57, v72
    v_lshlrev_b32 v82, 16, v200
    v_and_b32 v83, s57, v200
    v_pk_mul_f32 v[80:81], v[80:81], v[82:83]
    v_cvt_pk_bf16_f32 v72, v80, v81
    v_lshlrev_b32 v84, 16, v73
    v_and_b32 v85, s57, v73
    v_lshlrev_b32 v86, 16, v201
    v_and_b32 v87, s57, v201
    v_pk_mul_f32 v[84:85], v[84:85], v[86:87]
    v_cvt_pk_bf16_f32 v73, v84, v85
    v_lshlrev_b32 v80, 16, v74
    v_and_b32 v81, s57, v74
    v_lshlrev_b32 v82, 16, v202
    v_and_b32 v83, s57, v202
    v_pk_mul_f32 v[80:81], v[80:81], v[82:83]
    v_cvt_pk_bf16_f32 v74, v80, v81
    v_lshlrev_b32 v84, 16, v75
    v_and_b32 v85, s57, v75
    v_lshlrev_b32 v86, 16, v203
    v_and_b32 v87, s57, v203
    v_pk_mul_f32 v[84:85], v[84:85], v[86:87]
    v_cvt_pk_bf16_f32 v75, v84, v85
    buffer_store_dwordx4 v[72:75], v15, s[36:39], s6 offen
    s_add_u32 s6, s6, 163840
    s_waitcnt lgkmcnt(0)
    v_lshlrev_b32 v80, 16, v76
    v_and_b32 v81, s57, v76
    v_lshlrev_b32 v82, 16, v204
    v_and_b32 v83, s57, v204
    v_pk_mul_f32 v[80:81], v[80:81], v[82:83]
    v_cvt_pk_bf16_f32 v76, v80, v81
    v_lshlrev_b32 v84, 16, v77
    v_and_b32 v85, s57, v77
    v_lshlrev_b32 v86, 16, v205
    v_and_b32 v87, s57, v205
    v_pk_mul_f32 v[84:85], v[84:85], v[86:87]
    v_cvt_pk_bf16_f32 v77, v84, v85
    v_lshlrev_b32 v80, 16, v78
    v_and_b32 v81, s57, v78
    v_lshlrev_b32 v82, 16, v206
    v_and_b32 v83, s57, v206
    v_pk_mul_f32 v[80:81], v[80:81], v[82:83]
    v_cvt_pk_bf16_f32 v78, v80, v81
    v_lshlrev_b32 v84, 16, v79
    v_and_b32 v85, s57, v79
    v_lshlrev_b32 v86, 16, v207
    v_and_b32 v87, s57, v207
    v_pk_mul_f32 v[84:85], v[84:85], v[86:87]
    v_cvt_pk_bf16_f32 v79, v84, v85
    buffer_store_dwordx4 v[76:79], v15, s[36:39], s6 offen
K_FIN:
K_END:
    s_endpgm
.section .rodata,"a"
.p2align 6
.amdhsa_kernel concat_heads__ssm_conv_h3__sliding_local_dilated__prompt_kernel
  .amdhsa_next_free_vgpr 256
  .amdhsa_next_free_sgpr 102
  .amdhsa_accum_offset 256
  .amdhsa_group_segment_fixed_size 0
  .amdhsa_kernarg_size 96
  .amdhsa_user_sgpr_count 2
  .amdhsa_user_sgpr_kernarg_segment_ptr 1
  .amdhsa_system_sgpr_workgroup_id_x 1
  .amdhsa_float_denorm_mode_32 3
  .amdhsa_float_denorm_mode_16_64 3
.end_amdhsa_kernel
```
